```python
import torch

def _softmax(x, axis=-1):
    return torch.softmax(x, dim=axis)
def _gelu(x):
    return torch.nn.functional.gelu(x, approximate="tanh")
def _silu(x):
    return torch.nn.functional.silu(x)
def _sigmoid(x):
    return torch.sigmoid(x)
def _layernorm(x, axis=-1, eps=1e-5):
    m = x.mean(dim=axis, keepdim=True)
    v = x.var(dim=axis, keepdim=True, unbiased=False)
    return (x - m) / torch.sqrt(v + eps)
def _scatter_add(tgt, idx, src, axis=0):
    return tgt.clone().index_add_(axis, idx, src)
def _segment_sum(src, seg, n):
    out = torch.zeros((n,) + src.shape[1:], dtype=src.dtype)
    return out.index_add_(0, seg, src)
def _pad(x, pw):
    flat = tuple(v for pair in reversed(pw) for v in pair)
    return torch.nn.functional.pad(x, flat)

kernel_name = 'interleave_layers__gqa_block_cached__sliding_block_cached__decode'

def setup_inputs():

    _w = (lambda a: (lambda t: t.to(torch.bfloat16) if t.is_floating_point() else t)(torch.as_tensor(a)))
    def _A_setup():
        B, Sq, D = 1, 1, 448
        Hq, Hkv, Sk, Dh = 16, 8, 16384, 256
        assert Hq % Hkv == 0, (Hq, Hkv)
        return {
            "x": _w((lambda *s: torch.randn(*s, dtype=torch.bfloat16) * 0.1)(B, Sq, D)),
            "k_cache": _w((lambda *s: torch.randn(*s, dtype=torch.bfloat16) * 0.8)(B, Hkv, Sk, Dh)),
            "v_cache": _w((lambda *s: torch.randn(*s, dtype=torch.bfloat16) * 3.2)(B, Hkv, Sk, Dh)),
            "wq": _w((lambda *s: torch.randn(*s, dtype=torch.bfloat16) * 0.8)(D, Hq * Dh) * (D ** -0.5)),
            "wo": _w((lambda *s: torch.randn(*s, dtype=torch.bfloat16) * 3.2)(Hq * Dh, D) * ((Hq * Dh) ** -0.5)),
        }
    _A_in = _A_setup()

    def _B_setup():
        B, Sq, D = 1, 1, 448
        Hq, Hkv, Sk, Dh = 16, 8, 16384, 256
        assert Hq % Hkv == 0, (Hq, Hkv)
        return {
            "x": _w((lambda *s: torch.randn(*s, dtype=torch.bfloat16) * 0.1)(B, Sq, D)),
            "k_cache": _w((lambda *s: torch.randn(*s, dtype=torch.bfloat16) * 1.6)(B, Hkv, Sk, Dh)),
            "v_cache": _w((lambda *s: torch.randn(*s, dtype=torch.bfloat16) * 1.6)(B, Hkv, Sk, Dh)),
            "wq": _w((lambda *s: torch.randn(*s, dtype=torch.bfloat16) * 1.6)(D, Hq * Dh) * (D ** -0.5)),
            "wo": _w((lambda *s: torch.randn(*s, dtype=torch.bfloat16) * 1.6)(Hq * Dh, D) * ((Hq * Dh) ** -0.5)),
        }
    _B_in = _B_setup()

    return {
        "A_x": _A_in["x"],
        "A_k_cache": _A_in["k_cache"],
        "A_v_cache": _A_in["v_cache"],
        "A_wq": _A_in["wq"],
        "A_wo": _A_in["wo"],
        "B_x": _B_in["x"],
        "B_k_cache": _B_in["k_cache"],
        "B_v_cache": _B_in["v_cache"],
        "B_wq": _B_in["wq"],
        "B_wo": _B_in["wo"],
    }

def reference(A_x, A_k_cache, A_v_cache, A_wq, A_wo, B_x, B_k_cache, B_v_cache, B_wq, B_wo):
    def _A_ref(x, k_cache, v_cache, wq, wo):
        B, Sq, D = x.shape
        Hq, Dh = 16, 256
        Hkv = k_cache.shape[1]
        rep = Hq // Hkv
        q = (lambda x, *d: x.permute(*d))((x @ wq).reshape(B, Sq, Hq, Dh), 0, 2, 1, 3)
        k = (lambda x, n, axis: torch.repeat_interleave(x, n, dim=axis))(k_cache, rep, axis=1)
        v = (lambda x, n, axis: torch.repeat_interleave(x, n, dim=axis))(v_cache, rep, axis=1)
        scores = torch.einsum("bhqd,bhkd->bhqk", q, k) * (Dh ** -0.5)
        p = _softmax(scores, axis=-1)
        o = torch.einsum("bhqk,bhkd->bhqd", p, v)
        return (lambda x, *d: x.permute(*d))(o, 0, 2, 1, 3).reshape(B, Sq, Hq * Dh) @ wo

    def _B_ref(x, k_cache, v_cache, wq, wo):
        B, Sq, D = x.shape
        Hq, Dh = 16, 256
        Hkv, Sk = k_cache.shape[1], k_cache.shape[2]
        W = min(4096, max(256, Sk // 4))
        rep = Hq // Hkv
        q = (lambda x, *d: x.permute(*d))((x @ wq).reshape(B, Sq, Hq, Dh), 0, 2, 1, 3)
        k = (lambda x, n, axis: torch.repeat_interleave(x, n, dim=axis))(k_cache[:, :, Sk - W:, :], rep, axis=1)
        v = (lambda x, n, axis: torch.repeat_interleave(x, n, dim=axis))(v_cache[:, :, Sk - W:, :], rep, axis=1)
        scores = torch.einsum("bhqd,bhkd->bhqk", q, k) * (Dh ** -0.5)
        p = _softmax(scores, axis=-1)
        o = torch.einsum("bhqk,bhkd->bhqd", p, v)
        return (lambda x, *d: x.permute(*d))(o, 0, 2, 1, 3).reshape(B, Sq, Hq * Dh) @ wo

    x = A_x
    x = x + _A_ref(_layernorm(x, axis=-1), A_k_cache, A_v_cache, A_wq, A_wo)
    x = x + _B_ref(_layernorm(x, axis=-1), B_k_cache, B_v_cache, B_wq, B_wo)
    x = x + _A_ref(_layernorm(x, axis=-1), A_k_cache, A_v_cache, A_wq, A_wo)
    x = x + _B_ref(_layernorm(x, axis=-1), B_k_cache, B_v_cache, B_wq, B_wo)
    return x
```

```asm
; @launch grid=(256,1,1) block=(256,1,1) lds=163840
.amdgcn_target "amdgcn-amd-amdhsa--gfx950"
.text
.globl interleave_layers__gqa_block_cached__sliding_block_cached__decode_kernel
.p2align 8
.type interleave_layers__gqa_block_cached__sliding_block_cached__decode_kernel,@function
interleave_layers__gqa_block_cached__sliding_block_cached__decode_kernel:
    s_cmp_ge_u32 s2, 256
    s_cbranch_scc1 L_end
    s_load_dwordx16 s[52:67], s[0:1], 0
    s_load_dwordx8 s[68:75], s[0:1], 64
    s_load_dwordx2 s[76:77], s[0:1], 96
    v_lshrrev_b32 v1, 6, v0
    v_and_b32 v0, 63, v0
    s_and_b32 s48, s2, 7
    s_lshr_b32 s49, s2, 3
    v_readfirstlane_b32 s3, v1
    s_cmp_lt_u32 s49, 4
    s_cbranch_scc1 L_chain
    s_sub_u32 s49, s49, 4
    s_mul_i32 s39, s49, 36
    s_min_u32 s40, s49, 16
    s_add_u32 s39, s39, s40
    s_lshl_b32 s39, s39, 13
    s_lshl_b32 s41, s48, 23
    s_add_u32 s29, s39, s41
    s_lshl_b32 s38, s3, 12
    s_add_u32 s28, s29, s38
    s_mul_i32 s37, s3, 38912
    v_lshrrev_b32 v20, 4, v0
    v_and_b32 v21, 15, v0
    v_lshlrev_b32 v25, 4, v21
    v_lshl_add_u32 v2, v20, 9, v25
    v_add_u32 v4, 768, v2
    s_waitcnt lgkmcnt(0)
    s_mov_b32 s8, s56
    s_and_b32 s9, s57, 0xffff
    s_mov_b32 s10, 67108864
    s_mov_b32 s11, 0x20000
    s_add_u32 s39, s28, 146688
    s_add_u32 s40, s37, 0
    s_mov_b32 m0, s40
    s_nop 0
    buffer_load_dwordx4 v4, s[8:11], s39 offen offset:0 nt lds
    s_waitcnt vmcnt(4)
    buffer_load_dwordx4 v2, s[8:11], s39 offen offset:1024 nt lds
    s_waitcnt vmcnt(4)
    buffer_load_dwordx4 v4, s[8:11], s39 offen offset:2048 nt lds
    s_waitcnt vmcnt(4)
    buffer_load_dwordx4 v2, s[8:11], s39 offen offset:3072 nt lds
    s_waitcnt vmcnt(4)
    s_mov_b32 s36, 1035512379
    s_mov_b32 s43, 262144
    s_mov_b32 s42, 0
    s_getreg_b32 s34, hwreg(HW_REG_XCC_ID, 0, 4)
    s_min_u32 s34, s34, 14
    s_add_u32 s34, s34, 1
    s_mul_i32 s34, s34, 0x01010101
    s_mov_b32 s35, 0
    s_mov_b32 s20, s76
    s_and_b32 s21, s77, 0xffff
    s_mov_b32 s22, 283117312
    s_mov_b32 s23, 0x20000
    s_mov_b32 s24, s74
    s_and_b32 s25, s75, 0xffff
    s_mov_b32 s26, 256
    s_mov_b32 s27, 0x20000
    s_mov_b32 s4, s54
    s_and_b32 s5, s55, 0xffff
    s_mov_b32 s6, 67108864
    s_mov_b32 s7, 0x20000
    s_mov_b32 s12, s64
    s_and_b32 s13, s65, 0xffff
    s_mov_b32 s14, 67108864
    s_mov_b32 s15, 0x20000
    s_mov_b32 s16, s66
    s_and_b32 s17, s67, 0xffff
    s_mov_b32 s18, 67108864
    s_mov_b32 s19, 0x20000
    v_and_b32 v36, 7, v0
    v_lshlrev_b32 v36, 5, v36
    s_cmp_eq_u32 s3, 0
    s_cbranch_scc0 L_nc
    v_mov_b32 v7, s34
    s_lshl_b64 exec, 1, s48
    buffer_store_byte v7, v36, s[24:27], s49 offen offset:4 sc1
    s_mov_b64 exec, -1
L_nc:
    s_cmp_lt_u32 s49, 16
    s_cselect_b32 s40, 36, 35
    s_cselect_b32 s32, 0, 4286578688
    s_lshl_b32 s40, s40, 13
    s_lshl_b32 s38, s3, 11
    s_add_u32 s40, s40, s38
    s_add_u32 s29, s29, s40
    s_mul_i32 s39, s49, 9
    s_max_u32 s40, s49, 24
    s_sub_u32 s40, s40, 24
    s_add_u32 s39, s39, s40
    s_lshl_b32 s39, s39, 13
    s_add_u32 s39, s39, s41
    s_add_u32 s39, s39, 6291456
    s_lshl_b32 s40, s3, 12
    s_add_u32 s30, s39, s40
    s_add_u32 s50, s39, s38
    s_add_u32 s50, s50, 65536
    s_cmp_ge_u32 s49, 24
    s_cselect_b32 s39, 1, 0
    s_cselect_b32 s33, 0, 4286578688
    s_lshl_b32 s39, s39, 13
    s_add_u32 s31, s50, s39
    s_add_u32 s52, s30, 0
    s_add_u32 s53, s30, 16384
    s_add_u32 s54, s30, 32768
    s_add_u32 s55, s30, 49152
    s_mov_b32 s56, s50
    s_mov_b32 s57, s31
    v_and_b32 v22, 3, v0
    v_bfe_u32 v23, v0, 2, 2
    v_lshl_add_u32 v24, v20, 2, v22
    v_lshlrev_b32 v24, 4, v24
    v_lshl_add_u32 v1, v23, 9, v24
    v_lshl_add_u32 v5, v0, 4, s37
    v_lshrrev_b32 v27, 3, v21
    v_lshl_add_u32 v6, v27, 9, v24
    v_lshrrev_b32 v27, 5, v0
    v_mul_u32_u24 v27, 28672, v27
    v_lshl_add_u32 v27, v21, 5, v27
    v_and_b32 v28, 1, v20
    v_lshl_add_u32 v35, v28, 4, v27
    s_lshl_b32 s44, s48, 10
    s_mul_i32 s45, s48, 56
    s_add_u32 s45, s45, s49
    s_lshl_b32 s45, s45, 10
    s_add_u32 s45, s45, 196608
    s_lshl_b32 s46, s48, 13
    s_lshl_b32 s38, s49, 7
    s_add_u32 s46, s46, s38
    s_add_u32 s46, s46, 2031616
    v_and_b32 v20, 1, v0
    v_lshlrev_b32 v20, 4, v20
    v_mov_b32 v21, 0xffff
    v_lshlrev_b32 v20, v20, v21
    v_bfe_u32 v21, v0, 1, 2
    v_cmp_eq_u32 vcc, 0, v21
    s_nop 1
    v_cndmask_b32 v8, 0, v20, vcc
    v_cmp_eq_u32 vcc, 1, v21
    s_nop 1
    v_cndmask_b32 v9, 0, v20, vcc
    v_cmp_eq_u32 vcc, 2, v21
    s_nop 1
    v_cndmask_b32 v10, 0, v20, vcc
    v_cmp_eq_u32 vcc, 3, v21
    s_nop 1
    v_cndmask_b32 v11, 0, v20, vcc
    s_add_u32 s39, s28, 163072
    s_add_u32 s40, s37, 4096
    s_mov_b32 m0, s40
    s_nop 0
    buffer_load_dwordx4 v4, s[8:11], s39 offen offset:0 nt lds
    s_waitcnt vmcnt(4)
    buffer_load_dwordx4 v2, s[8:11], s39 offen offset:1024 nt lds
    s_waitcnt vmcnt(4)
    buffer_load_dwordx4 v4, s[8:11], s39 offen offset:2048 nt lds
    s_waitcnt vmcnt(4)
    buffer_load_dwordx4 v2, s[8:11], s39 offen offset:3072 nt lds
    s_waitcnt vmcnt(4)
    s_add_u32 s39, s28, 179456
    s_add_u32 s40, s37, 8192
    s_mov_b32 m0, s40
    s_nop 0
    buffer_load_dwordx4 v4, s[8:11], s39 offen offset:0 nt lds
    s_waitcnt vmcnt(4)
    buffer_load_dwordx4 v2, s[8:11], s39 offen offset:1024 nt lds
    s_waitcnt vmcnt(4)
    buffer_load_dwordx4 v4, s[8:11], s39 offen offset:2048 nt lds
    s_waitcnt vmcnt(4)
    buffer_load_dwordx4 v2, s[8:11], s39 offen offset:3072 nt lds
    s_waitcnt vmcnt(4)
    s_add_u32 s39, s28, 195840
    s_add_u32 s40, s37, 12288
    s_mov_b32 m0, s40
    s_nop 0
    buffer_load_dwordx4 v4, s[8:11], s39 offen offset:0 nt lds
    s_waitcnt vmcnt(4)
    buffer_load_dwordx4 v2, s[8:11], s39 offen offset:1024 nt lds
    s_waitcnt vmcnt(4)
    buffer_load_dwordx4 v4, s[8:11], s39 offen offset:2048 nt lds
    s_waitcnt vmcnt(4)
    buffer_load_dwordx4 v2, s[8:11], s39 offen offset:3072 nt lds
    s_waitcnt vmcnt(4)
    s_add_u32 s39, s28, 212224
    s_add_u32 s40, s37, 16384
    s_mov_b32 m0, s40
    s_nop 0
    buffer_load_dwordx4 v4, s[8:11], s39 offen offset:0 nt lds
    s_waitcnt vmcnt(4)
    buffer_load_dwordx4 v2, s[8:11], s39 offen offset:1024 nt lds
    s_waitcnt vmcnt(4)
    buffer_load_dwordx4 v4, s[8:11], s39 offen offset:2048 nt lds
    s_waitcnt vmcnt(4)
    buffer_load_dwordx4 v2, s[8:11], s39 offen offset:3072 nt lds
    s_waitcnt vmcnt(4)
    s_add_u32 s39, s28, 228608
    s_add_u32 s40, s37, 20480
    s_mov_b32 m0, s40
    s_nop 0
    buffer_load_dwordx4 v4, s[8:11], s39 offen offset:0 nt lds
    s_waitcnt vmcnt(4)
    buffer_load_dwordx4 v2, s[8:11], s39 offen offset:1024 nt lds
    s_waitcnt vmcnt(4)
    buffer_load_dwordx4 v4, s[8:11], s39 offen offset:2048 nt lds
    s_waitcnt vmcnt(4)
    buffer_load_dwordx4 v2, s[8:11], s39 offen offset:3072 nt lds
    s_waitcnt vmcnt(4)
    s_add_u32 s39, s28, 244992
    s_add_u32 s40, s37, 24576
    s_mov_b32 m0, s40
    s_nop 0
    buffer_load_dwordx4 v4, s[8:11], s39 offen offset:0 nt lds
    s_waitcnt vmcnt(4)
    buffer_load_dwordx4 v2, s[8:11], s39 offen offset:1024 nt lds
    s_waitcnt vmcnt(4)
    buffer_load_dwordx4 v4, s[8:11], s39 offen offset:2048 nt lds
    s_waitcnt vmcnt(4)
    buffer_load_dwordx4 v2, s[8:11], s39 offen offset:3072 nt lds
    s_waitcnt vmcnt(4)
    s_add_u32 s39, s28, 261376
    s_add_u32 s40, s37, 28672
    s_mov_b32 m0, s40
    s_nop 0
    buffer_load_dwordx4 v4, s[8:11], s39 offen offset:0 nt lds
    s_waitcnt vmcnt(4)
    buffer_load_dwordx4 v2, s[8:11], s39 offen offset:1024 nt lds
    s_waitcnt vmcnt(4)
    buffer_load_dwordx4 v4, s[8:11], s39 offen offset:2048 nt lds
    s_waitcnt vmcnt(4)
    buffer_load_dwordx4 v2, s[8:11], s39 offen offset:3072 nt lds
    s_waitcnt vmcnt(4)
    s_add_u32 s39, s28, 277760
    s_add_u32 s40, s37, 32768
    s_mov_b32 m0, s40
    s_nop 0
    buffer_load_dwordx4 v4, s[8:11], s39 offen offset:0 nt lds
    s_waitcnt vmcnt(4)
    buffer_load_dwordx4 v2, s[8:11], s39 offen offset:1024 nt lds
    s_waitcnt vmcnt(4)
    buffer_load_dwordx4 v4, s[8:11], s39 offen offset:2048 nt lds
    s_waitcnt vmcnt(4)
    buffer_load_dwordx4 v2, s[8:11], s39 offen offset:3072 nt lds
    s_waitcnt vmcnt(4)
    s_sub_u32 s39, s29, 768
    s_add_u32 s40, s37, 36864
    s_mov_b32 m0, s40
    s_nop 0
    buffer_load_dwordx4 v4, s[8:11], s39 offen offset:0 nt lds
    s_waitcnt vmcnt(4)
    buffer_load_dwordx4 v2, s[8:11], s39 offen offset:1024 nt lds
    s_waitcnt vmcnt(4)
    s_add_u32 s38, s28, 0
    buffer_load_dwordx4 v[72:75], v1, s[4:7], s38 offen offset:0 nt
    s_waitcnt vmcnt(4)
    buffer_load_dwordx4 v[76:79], v1, s[4:7], s38 offen offset:256 nt
    s_waitcnt vmcnt(4)
    buffer_load_dwordx4 v[80:83], v1, s[4:7], s38 offen offset:2048 nt
    s_waitcnt vmcnt(4)
    buffer_load_dwordx4 v[84:87], v1, s[4:7], s38 offen offset:2304 nt
    s_waitcnt vmcnt(4)
    s_add_u32 s38, s28, 16384
    buffer_load_dwordx4 v[88:91], v1, s[4:7], s38 offen offset:0 nt
    s_waitcnt vmcnt(4)
    buffer_load_dwordx4 v[92:95], v1, s[4:7], s38 offen offset:256 nt
    s_waitcnt vmcnt(4)
    buffer_load_dwordx4 v[96:99], v1, s[4:7], s38 offen offset:2048 nt
    s_waitcnt vmcnt(4)
    buffer_load_dwordx4 v[100:103], v1, s[4:7], s38 offen offset:2304 nt
    s_waitcnt vmcnt(4)
    s_add_u32 s38, s28, 32768
    buffer_load_dwordx4 v[104:107], v1, s[4:7], s38 offen offset:0 nt
    s_waitcnt vmcnt(4)
    buffer_load_dwordx4 v[108:111], v1, s[4:7], s38 offen offset:256 nt
    s_waitcnt vmcnt(4)
    buffer_load_dwordx4 v[112:115], v1, s[4:7], s38 offen offset:2048 nt
    s_waitcnt vmcnt(4)
    buffer_load_dwordx4 v[116:119], v1, s[4:7], s38 offen offset:2304 nt
    s_waitcnt vmcnt(4)
    s_add_u32 s38, s28, 49152
    buffer_load_dwordx4 v[120:123], v1, s[4:7], s38 offen offset:0 nt
    s_waitcnt vmcnt(4)
    buffer_load_dwordx4 v[124:127], v1, s[4:7], s38 offen offset:256 nt
    s_waitcnt vmcnt(4)
    buffer_load_dwordx4 v[128:131], v1, s[4:7], s38 offen offset:2048 nt
    s_waitcnt vmcnt(4)
    buffer_load_dwordx4 v[132:135], v1, s[4:7], s38 offen offset:2304 nt
    s_waitcnt vmcnt(4)
    s_add_u32 s38, s28, 65536
    buffer_load_dwordx4 v[136:139], v1, s[4:7], s38 offen offset:0 nt
    s_waitcnt vmcnt(4)
    buffer_load_dwordx4 v[140:143], v1, s[4:7], s38 offen offset:256 nt
    s_waitcnt vmcnt(4)
    buffer_load_dwordx4 v[144:147], v1, s[4:7], s38 offen offset:2048 nt
    s_waitcnt vmcnt(4)
    buffer_load_dwordx4 v[148:151], v1, s[4:7], s38 offen offset:2304 nt
    s_waitcnt vmcnt(4)
    buffer_load_dword v32, v36, s[24:27], 0 offen sc1
    s_waitcnt vmcnt(4)
    s_add_u32 s38, s28, 81920
    buffer_load_dwordx4 v[152:155], v1, s[4:7], s38 offen offset:0 nt
    s_waitcnt vmcnt(4)
    buffer_load_dwordx4 v[156:159], v1, s[4:7], s38 offen offset:256 nt
    s_waitcnt vmcnt(4)
    buffer_load_dwordx4 v[160:163], v1, s[4:7], s38 offen offset:2048 nt
    s_waitcnt vmcnt(4)
    buffer_load_dwordx4 v[164:167], v1, s[4:7], s38 offen offset:2304 nt
    s_waitcnt vmcnt(4)
    s_add_u32 s38, s28, 98304
    buffer_load_dwordx4 v[168:171], v1, s[4:7], s38 offen offset:0 nt
    s_waitcnt vmcnt(4)
    buffer_load_dwordx4 v[172:175], v1, s[4:7], s38 offen offset:256 nt
    s_waitcnt vmcnt(4)
    buffer_load_dwordx4 v[176:179], v1, s[4:7], s38 offen offset:2048 nt
    s_waitcnt vmcnt(4)
    buffer_load_dwordx4 v[180:183], v1, s[4:7], s38 offen offset:2304 nt
    s_waitcnt vmcnt(4)
    s_add_u32 s38, s28, 114688
    buffer_load_dwordx4 v[184:187], v1, s[4:7], s38 offen offset:0 nt
    s_waitcnt vmcnt(4)
    buffer_load_dwordx4 v[188:191], v1, s[4:7], s38 offen offset:256 nt
    s_waitcnt vmcnt(4)
    buffer_load_dwordx4 v[192:195], v1, s[4:7], s38 offen offset:2048 nt
    s_waitcnt vmcnt(4)
    buffer_load_dwordx4 v[196:199], v1, s[4:7], s38 offen offset:2304 nt
    s_waitcnt vmcnt(4)
    s_add_u32 s38, s28, 131072
    buffer_load_dwordx4 v[200:203], v1, s[4:7], s38 offen offset:0 nt
    s_waitcnt vmcnt(4)
    buffer_load_dwordx4 v[204:207], v1, s[4:7], s38 offen offset:256 nt
    s_waitcnt vmcnt(4)
    buffer_load_dwordx4 v[208:211], v1, s[4:7], s38 offen offset:2048 nt
    s_waitcnt vmcnt(4)
    buffer_load_dwordx4 v[212:215], v1, s[4:7], s38 offen offset:2304 nt
    s_waitcnt vmcnt(4)
    s_add_u32 s38, s28, 147456
    buffer_load_dwordx4 v[216:219], v1, s[4:7], s38 offen offset:0 nt
    s_waitcnt vmcnt(4)
    buffer_load_dwordx4 v[220:223], v1, s[4:7], s38 offen offset:256 nt
    s_waitcnt vmcnt(4)
    buffer_load_dwordx4 v[224:227], v1, s[4:7], s38 offen offset:2048 nt
    s_waitcnt vmcnt(4)
    buffer_load_dwordx4 v[228:231], v1, s[4:7], s38 offen offset:2304 nt
    s_waitcnt vmcnt(4)
    s_waitcnt vmcnt(20)
    s_branch L_cack_3
L_calp_2:
    s_cmp_eq_u32 s43, 0
    s_cbranch_scc1 L_caok_1
    s_sub_u32 s43, s43, 1
    buffer_load_dword v32, v36, s[24:27], 0 offen sc1
    s_waitcnt vmcnt(0)
L_cack_3:
    v_readlane_b32 s41, v32, s48
    s_cmp_eq_u32 s41, s34
    s_cselect_b32 s35, 1, 0
    s_add_u32 s41, s41, 0x7f7f7f7f
    s_and_b32 s41, s41, 0x80808080
    s_cmp_eq_u32 s41, 0x80808080
    s_cbranch_scc0 L_calp_2
L_caok_1:
    s_cmp_lt_u32 s3, 2
    s_cbranch_scc1 L_clsk_4
    v_mov_b32 v20, -1
    v_mov_b32 v21, -1
    v_mov_b32 v22, -1
    v_mov_b32 v23, -1
    v_lshlrev_b32 v7, 4, v0
    s_sub_u32 s41, s3, 2
    s_lshl_b32 s47, s41, 12
    s_add_u32 s47, s47, s46
    s_add_u32 s47, s47, 65536
    s_mul_i32 s41, s41, 28672
    s_add_u32 s41, s41, s45
    s_add_u32 s41, s41, 458752
    s_cmp_eq_u32 s35, 1
    s_cbranch_scc0 L_clfar_5
    buffer_store_dwordx4 v[20:23], v7, s[20:23], s41 offen
    s_mov_b64 exec, 1
    buffer_store_dwordx2 v[20:21], v7, s[20:23], s47 offen
    s_mov_b64 exec, -1
    s_branch L_clsk_4
L_clfar_5:
    buffer_store_dwordx4 v[20:23], v7, s[20:23], s41 offen sc1
    s_mov_b64 exec, 1
    buffer_store_dwordx2 v[20:21], v7, s[20:23], s47 offen sc1
    s_mov_b64 exec, -1
L_clsk_4:
    s_nop 1
    buffer_load_dwordx4 v[12:15], v6, s[20:23], s44 offen sc1
    buffer_load_dwordx4 v[16:19], v6, s[20:23], s44 offen offset:256 sc1
    s_add_u32 s38, s28, 163840
    buffer_load_dwordx4 v[232:235], v1, s[4:7], s38 offen offset:0 nt
    s_waitcnt vmcnt(4)
    buffer_load_dwordx4 v[236:239], v1, s[4:7], s38 offen offset:256 nt
    s_waitcnt vmcnt(4)
    buffer_load_dwordx4 v[240:243], v1, s[4:7], s38 offen offset:2048 nt
    s_waitcnt vmcnt(4)
    buffer_load_dwordx4 v[244:247], v1, s[4:7], s38 offen offset:2304 nt
    s_waitcnt vmcnt(4)
    s_add_u32 s38, s28, 180224
    buffer_load_dwordx4 v[248:251], v1, s[4:7], s38 offen offset:0 nt
    s_waitcnt vmcnt(4)
    buffer_load_dwordx4 v[252:255], v1, s[4:7], s38 offen offset:256 nt
    s_waitcnt vmcnt(4)
    buffer_load_dwordx4 a[0:3], v1, s[4:7], s38 offen offset:2048 nt
    s_waitcnt vmcnt(4)
    buffer_load_dwordx4 a[4:7], v1, s[4:7], s38 offen offset:2304 nt
    s_waitcnt vmcnt(4)
    s_add_u32 s38, s28, 196608
    buffer_load_dwordx4 a[8:11], v1, s[4:7], s38 offen offset:0 nt
    s_waitcnt vmcnt(4)
    buffer_load_dwordx4 a[12:15], v1, s[4:7], s38 offen offset:256 nt
    s_waitcnt vmcnt(4)
    buffer_load_dwordx4 a[16:19], v1, s[4:7], s38 offen offset:2048 nt
    s_waitcnt vmcnt(4)
    buffer_load_dwordx4 a[20:23], v1, s[4:7], s38 offen offset:2304 nt
    s_waitcnt vmcnt(4)
    s_waitcnt vmcnt(12)
    v_max3_u32 v7, v12, v13, v14
    v_max3_u32 v7, v7, v15, v16
    v_max3_u32 v7, v7, v17, v18
    v_max_u32 v7, v7, v19
    v_cmp_eq_u32 vcc, -1, v7
    s_nop 0
    s_cmp_lg_u64 vcc, 0
    s_cbranch_scc1 L_qslow_6
    s_branch L_qok_7
L_qslow_6:
L_qpoll_8:
    s_cmp_eq_u32 s43, 0
    s_cbranch_scc1 L_qdone_9
    s_sub_u32 s43, s43, 1
    buffer_load_dwordx4 v[12:15], v6, s[20:23], s44 offen sc1
    buffer_load_dwordx4 v[16:19], v6, s[20:23], s44 offen offset:256 sc1
    s_waitcnt vmcnt(0)
    v_max3_u32 v7, v12, v13, v14
    v_max3_u32 v7, v7, v15, v16
    v_max3_u32 v7, v7, v17, v18
    v_max_u32 v7, v7, v19
    v_cmp_eq_u32 vcc, -1, v7
    s_nop 0
    s_cmp_lg_u64 vcc, 0
    s_cbranch_scc1 L_qpoll_8
L_qdone_9:
    s_nop 1
L_qok_7:
    s_lshl_b32 s58, s3, 2
    v_lshrrev_b32 v3, 5, v0
    v_lshlrev_b32 v3, 4, v3
    v_add_u32 v3, 161792, v3
    v_bfe_u32 v4, v0, 3, 1
    v_lshlrev_b32 v4, 4, v4
    v_add_u32 v4, s58, v4
    v_add_u32 v4, 161792, v4
    s_add_u32 s38, s28, 212992
    buffer_load_dwordx4 a[24:27], v1, s[4:7], s38 offen offset:0 nt
    s_waitcnt vmcnt(4)
    v_mov_b32 v34, 4286578688
    v_mov_b32 v55, 4286578688
    s_waitcnt vmcnt(54)
    v_mfma_f32_16x16x32_bf16 v[20:23], v[72:75], v[12:15], 0
    s_waitcnt vmcnt(54)
    v_mfma_f32_16x16x32_bf16 v[20:23], v[76:79], v[16:19], v[20:23]
    s_waitcnt vmcnt(52)
    v_mfma_f32_16x16x32_bf16 v[24:27], v[80:83], v[12:15], 0
    s_waitcnt vmcnt(52)
    v_mfma_f32_16x16x32_bf16 v[24:27], v[84:87], v[16:19], v[24:27]
    s_waitcnt vmcnt(50)
    v_mfma_f32_16x16x32_bf16 v[28:31], v[88:91], v[12:15], 0
    s_nop 4
    v_mov_b32_dpp v20, v20 quad_perm:[0,0,0,0] row_mask:0xf bank_mask:0xf
    s_waitcnt vmcnt(50)
    v_mfma_f32_16x16x32_bf16 v[28:31], v[92:95], v[16:19], v[28:31]
    buffer_load_dwordx4 a[28:31], v1, s[4:7], s38 offen offset:256 nt
    s_waitcnt vmcnt(4)
    v_add_f32_dpp v20, v21, v20 quad_perm:[1,1,1,1] row_mask:0xf bank_mask:0xf
    v_add_f32_dpp v20, v22, v20 quad_perm:[2,2,2,2] row_mask:0xf bank_mask:0xf
    v_add_f32_dpp v37, v23, v20 quad_perm:[3,3,3,3] row_mask:0xf bank_mask:0x5
    s_waitcnt vmcnt(49)
    v_mfma_f32_16x16x32_bf16 v[20:23], v[96:99], v[12:15], 0
    v_mov_b32_dpp v24, v24 quad_perm:[0,0,0,0] row_mask:0xf bank_mask:0xf
    v_add_f32_dpp v24, v25, v24 quad_perm:[1,1,1,1] row_mask:0xf bank_mask:0xf
    s_waitcnt vmcnt(49)
    v_mfma_f32_16x16x32_bf16 v[20:23], v[100:103], v[16:19], v[20:23]
    v_add_f32_dpp v24, v26, v24 quad_perm:[2,2,2,2] row_mask:0xf bank_mask:0xf
    v_add_f32_dpp v37, v27, v24 quad_perm:[3,3,3,3] row_mask:0xf bank_mask:0xa
    v_max_f32 v34, v34, v37
    s_waitcnt vmcnt(47)
    v_mfma_f32_16x16x32_bf16 v[24:27], v[104:107], v[12:15], 0
    v_mov_b32_dpp v28, v28 quad_perm:[0,0,0,0] row_mask:0xf bank_mask:0xf
    v_add_f32_dpp v28, v29, v28 quad_perm:[1,1,1,1] row_mask:0xf bank_mask:0xf
    s_waitcnt vmcnt(47)
    v_mfma_f32_16x16x32_bf16 v[24:27], v[108:111], v[16:19], v[24:27]
    buffer_load_dwordx4 a[32:35], v1, s[4:7], s38 offen offset:2048 nt
    s_waitcnt vmcnt(4)
    v_add_f32_dpp v28, v30, v28 quad_perm:[2,2,2,2] row_mask:0xf bank_mask:0xf
    v_add_f32_dpp v38, v31, v28 quad_perm:[3,3,3,3] row_mask:0xf bank_mask:0x5
    s_waitcnt vmcnt(46)
    v_mfma_f32_16x16x32_bf16 v[28:31], v[112:115], v[12:15], 0
    v_mov_b32_dpp v20, v20 quad_perm:[0,0,0,0] row_mask:0xf bank_mask:0xf
    v_add_f32_dpp v20, v21, v20 quad_perm:[1,1,1,1] row_mask:0xf bank_mask:0xf
    s_waitcnt vmcnt(46)
    v_mfma_f32_16x16x32_bf16 v[28:31], v[116:119], v[16:19], v[28:31]
    v_add_f32_dpp v20, v22, v20 quad_perm:[2,2,2,2] row_mask:0xf bank_mask:0xf
    v_add_f32_dpp v38, v23, v20 quad_perm:[3,3,3,3] row_mask:0xf bank_mask:0xa
    v_max_f32 v34, v34, v38
    s_waitcnt vmcnt(44)
    v_mfma_f32_16x16x32_bf16 v[20:23], v[120:123], v[12:15], 0
    v_mov_b32_dpp v24, v24 quad_perm:[0,0,0,0] row_mask:0xf bank_mask:0xf
    v_add_f32_dpp v24, v25, v24 quad_perm:[1,1,1,1] row_mask:0xf bank_mask:0xf
    s_waitcnt vmcnt(44)
    v_mfma_f32_16x16x32_bf16 v[20:23], v[124:127], v[16:19], v[20:23]
    buffer_load_dwordx4 a[36:39], v1, s[4:7], s38 offen offset:2304 nt
    s_waitcnt vmcnt(4)
    v_add_f32_dpp v24, v26, v24 quad_perm:[2,2,2,2] row_mask:0xf bank_mask:0xf
    v_add_f32_dpp v39, v27, v24 quad_perm:[3,3,3,3] row_mask:0xf bank_mask:0x5
    s_waitcnt vmcnt(43)
    v_mfma_f32_16x16x32_bf16 v[24:27], v[128:131], v[12:15], 0
    v_mov_b32_dpp v28, v28 quad_perm:[0,0,0,0] row_mask:0xf bank_mask:0xf
    v_add_f32_dpp v28, v29, v28 quad_perm:[1,1,1,1] row_mask:0xf bank_mask:0xf
    s_waitcnt vmcnt(43)
    v_mfma_f32_16x16x32_bf16 v[24:27], v[132:135], v[16:19], v[24:27]
    v_add_f32_dpp v28, v30, v28 quad_perm:[2,2,2,2] row_mask:0xf bank_mask:0xf
    v_add_f32_dpp v39, v31, v28 quad_perm:[3,3,3,3] row_mask:0xf bank_mask:0xa
    v_max_f32 v34, v34, v39
    s_waitcnt vmcnt(41)
    v_mfma_f32_16x16x32_bf16 v[28:31], v[136:139], v[12:15], 0
    v_mov_b32_dpp v20, v20 quad_perm:[0,0,0,0] row_mask:0xf bank_mask:0xf
    v_add_f32_dpp v20, v21, v20 quad_perm:[1,1,1,1] row_mask:0xf bank_mask:0xf
    s_waitcnt vmcnt(41)
    v_mfma_f32_16x16x32_bf16 v[28:31], v[140:143], v[16:19], v[28:31]
    s_add_u32 s38, s28, 229376
    buffer_load_dwordx4 a[40:43], v1, s[4:7], s38 offen offset:0 nt
    s_waitcnt vmcnt(4)
    v_add_f32_dpp v20, v22, v20 quad_perm:[2,2,2,2] row_mask:0xf bank_mask:0xf
    v_add_f32_dpp v40, v23, v20 quad_perm:[3,3,3,3] row_mask:0xf bank_mask:0x5
    s_waitcnt vmcnt(40)
    v_mfma_f32_16x16x32_bf16 v[20:23], v[144:147], v[12:15], 0
    v_mov_b32_dpp v24, v24 quad_perm:[0,0,0,0] row_mask:0xf bank_mask:0xf
    v_add_f32_dpp v24, v25, v24 quad_perm:[1,1,1,1] row_mask:0xf bank_mask:0xf
    s_waitcnt vmcnt(40)
    v_mfma_f32_16x16x32_bf16 v[20:23], v[148:151], v[16:19], v[20:23]
    v_add_f32_dpp v24, v26, v24 quad_perm:[2,2,2,2] row_mask:0xf bank_mask:0xf
    v_add_f32_dpp v40, v27, v24 quad_perm:[3,3,3,3] row_mask:0xf bank_mask:0xa
    v_max_f32 v34, v34, v40
    s_waitcnt vmcnt(37)
    v_mfma_f32_16x16x32_bf16 v[24:27], v[152:155], v[12:15], 0
    v_mov_b32_dpp v28, v28 quad_perm:[0,0,0,0] row_mask:0xf bank_mask:0xf
    v_add_f32_dpp v28, v29, v28 quad_perm:[1,1,1,1] row_mask:0xf bank_mask:0xf
    s_waitcnt vmcnt(37)
    v_mfma_f32_16x16x32_bf16 v[24:27], v[156:159], v[16:19], v[24:27]
    buffer_load_dwordx4 a[44:47], v1, s[4:7], s38 offen offset:256 nt
    s_waitcnt vmcnt(4)
    v_add_f32_dpp v28, v30, v28 quad_perm:[2,2,2,2] row_mask:0xf bank_mask:0xf
    v_add_f32_dpp v41, v31, v28 quad_perm:[3,3,3,3] row_mask:0xf bank_mask:0x5
    s_waitcnt vmcnt(36)
    v_mfma_f32_16x16x32_bf16 v[28:31], v[160:163], v[12:15], 0
    v_mov_b32_dpp v20, v20 quad_perm:[0,0,0,0] row_mask:0xf bank_mask:0xf
    v_add_f32_dpp v20, v21, v20 quad_perm:[1,1,1,1] row_mask:0xf bank_mask:0xf
    s_waitcnt vmcnt(36)
    v_mfma_f32_16x16x32_bf16 v[28:31], v[164:167], v[16:19], v[28:31]
    v_add_f32_dpp v20, v22, v20 quad_perm:[2,2,2,2] row_mask:0xf bank_mask:0xf
    v_add_f32_dpp v41, v23, v20 quad_perm:[3,3,3,3] row_mask:0xf bank_mask:0xa
    v_max_f32 v34, v34, v41
    s_waitcnt vmcnt(34)
    v_mfma_f32_16x16x32_bf16 v[20:23], v[168:171], v[12:15], 0
    v_mov_b32_dpp v24, v24 quad_perm:[0,0,0,0] row_mask:0xf bank_mask:0xf
    v_add_f32_dpp v24, v25, v24 quad_perm:[1,1,1,1] row_mask:0xf bank_mask:0xf
    s_waitcnt vmcnt(34)
    v_mfma_f32_16x16x32_bf16 v[20:23], v[172:175], v[16:19], v[20:23]
    buffer_load_dwordx4 a[48:51], v1, s[4:7], s38 offen offset:2048 nt
    s_waitcnt vmcnt(4)
    v_add_f32_dpp v24, v26, v24 quad_perm:[2,2,2,2] row_mask:0xf bank_mask:0xf
    v_add_f32_dpp v42, v27, v24 quad_perm:[3,3,3,3] row_mask:0xf bank_mask:0x5
    s_waitcnt vmcnt(33)
    v_mfma_f32_16x16x32_bf16 v[24:27], v[176:179], v[12:15], 0
    v_mov_b32_dpp v28, v28 quad_perm:[0,0,0,0] row_mask:0xf bank_mask:0xf
    v_add_f32_dpp v28, v29, v28 quad_perm:[1,1,1,1] row_mask:0xf bank_mask:0xf
    s_waitcnt vmcnt(33)
    v_mfma_f32_16x16x32_bf16 v[24:27], v[180:183], v[16:19], v[24:27]
    v_add_f32_dpp v28, v30, v28 quad_perm:[2,2,2,2] row_mask:0xf bank_mask:0xf
    v_add_f32_dpp v42, v31, v28 quad_perm:[3,3,3,3] row_mask:0xf bank_mask:0xa
    v_max_f32 v34, v34, v42
    s_waitcnt vmcnt(31)
    v_mfma_f32_16x16x32_bf16 v[28:31], v[184:187], v[12:15], 0
    v_mov_b32_dpp v20, v20 quad_perm:[0,0,0,0] row_mask:0xf bank_mask:0xf
    v_add_f32_dpp v20, v21, v20 quad_perm:[1,1,1,1] row_mask:0xf bank_mask:0xf
    s_waitcnt vmcnt(31)
    v_mfma_f32_16x16x32_bf16 v[28:31], v[188:191], v[16:19], v[28:31]
    buffer_load_dwordx4 a[52:55], v1, s[4:7], s38 offen offset:2304 nt
    s_waitcnt vmcnt(4)
    v_add_f32_dpp v20, v22, v20 quad_perm:[2,2,2,2] row_mask:0xf bank_mask:0xf
    v_add_f32_dpp v43, v23, v20 quad_perm:[3,3,3,3] row_mask:0xf bank_mask:0x5
    s_waitcnt vmcnt(30)
    v_mfma_f32_16x16x32_bf16 v[20:23], v[192:195], v[12:15], 0
    v_mov_b32_dpp v24, v24 quad_perm:[0,0,0,0] row_mask:0xf bank_mask:0xf
    v_add_f32_dpp v24, v25, v24 quad_perm:[1,1,1,1] row_mask:0xf bank_mask:0xf
    s_waitcnt vmcnt(30)
    v_mfma_f32_16x16x32_bf16 v[20:23], v[196:199], v[16:19], v[20:23]
    v_add_f32_dpp v24, v26, v24 quad_perm:[2,2,2,2] row_mask:0xf bank_mask:0xf
    v_add_f32_dpp v43, v27, v24 quad_perm:[3,3,3,3] row_mask:0xf bank_mask:0xa
    v_max_f32 v34, v34, v43
    s_waitcnt vmcnt(28)
    v_mfma_f32_16x16x32_bf16 v[24:27], v[200:203], v[12:15], 0
    v_mov_b32_dpp v28, v28 quad_perm:[0,0,0,0] row_mask:0xf bank_mask:0xf
    v_add_f32_dpp v28, v29, v28 quad_perm:[1,1,1,1] row_mask:0xf bank_mask:0xf
    s_waitcnt vmcnt(28)
    v_mfma_f32_16x16x32_bf16 v[24:27], v[204:207], v[16:19], v[24:27]
    s_add_u32 s38, s28, 245760
    buffer_load_dwordx4 a[56:59], v1, s[4:7], s38 offen offset:0 nt
    s_waitcnt vmcnt(4)
    v_add_f32_dpp v28, v30, v28 quad_perm:[2,2,2,2] row_mask:0xf bank_mask:0xf
    v_add_f32_dpp v44, v31, v28 quad_perm:[3,3,3,3] row_mask:0xf bank_mask:0x5
    s_waitcnt vmcnt(27)
    v_mfma_f32_16x16x32_bf16 v[28:31], v[208:211], v[12:15], 0
    v_mov_b32_dpp v20, v20 quad_perm:[0,0,0,0] row_mask:0xf bank_mask:0xf
    v_add_f32_dpp v20, v21, v20 quad_perm:[1,1,1,1] row_mask:0xf bank_mask:0xf
    s_waitcnt vmcnt(27)
    v_mfma_f32_16x16x32_bf16 v[28:31], v[212:215], v[16:19], v[28:31]
    v_add_f32_dpp v20, v22, v20 quad_perm:[2,2,2,2] row_mask:0xf bank_mask:0xf
    v_add_f32_dpp v44, v23, v20 quad_perm:[3,3,3,3] row_mask:0xf bank_mask:0xa
    v_max_f32 v34, v34, v44
    s_waitcnt vmcnt(25)
    v_mfma_f32_16x16x32_bf16 v[20:23], v[216:219], v[12:15], 0
    v_mov_b32_dpp v24, v24 quad_perm:[0,0,0,0] row_mask:0xf bank_mask:0xf
    v_add_f32_dpp v24, v25, v24 quad_perm:[1,1,1,1] row_mask:0xf bank_mask:0xf
    s_waitcnt vmcnt(25)
    v_mfma_f32_16x16x32_bf16 v[20:23], v[220:223], v[16:19], v[20:23]
    buffer_load_dwordx4 a[60:63], v1, s[4:7], s38 offen offset:256 nt
    s_waitcnt vmcnt(4)
    v_add_f32_dpp v24, v26, v24 quad_perm:[2,2,2,2] row_mask:0xf bank_mask:0xf
    v_add_f32_dpp v45, v27, v24 quad_perm:[3,3,3,3] row_mask:0xf bank_mask:0x5
    s_waitcnt vmcnt(24)
    v_mfma_f32_16x16x32_bf16 v[24:27], v[224:227], v[12:15], 0
    v_mov_b32_dpp v28, v28 quad_perm:[0,0,0,0] row_mask:0xf bank_mask:0xf
    v_add_f32_dpp v28, v29, v28 quad_perm:[1,1,1,1] row_mask:0xf bank_mask:0xf
    s_waitcnt vmcnt(24)
    v_mfma_f32_16x16x32_bf16 v[24:27], v[228:231], v[16:19], v[24:27]
    v_add_f32_dpp v28, v30, v28 quad_perm:[2,2,2,2] row_mask:0xf bank_mask:0xf
    v_add_f32_dpp v45, v31, v28 quad_perm:[3,3,3,3] row_mask:0xf bank_mask:0xa
    v_max_f32 v34, v34, v45
    s_waitcnt vmcnt(20)
    v_mfma_f32_16x16x32_bf16 v[28:31], v[232:235], v[12:15], 0
    v_mov_b32_dpp v20, v20 quad_perm:[0,0,0,0] row_mask:0xf bank_mask:0xf
    v_add_f32_dpp v20, v21, v20 quad_perm:[1,1,1,1] row_mask:0xf bank_mask:0xf
    s_waitcnt vmcnt(20)
    v_mfma_f32_16x16x32_bf16 v[28:31], v[236:239], v[16:19], v[28:31]
    buffer_load_dwordx4 a[64:67], v1, s[4:7], s38 offen offset:2048 nt
    s_waitcnt vmcnt(4)
    v_add_f32_dpp v20, v22, v20 quad_perm:[2,2,2,2] row_mask:0xf bank_mask:0xf
    v_add_f32_dpp v46, v23, v20 quad_perm:[3,3,3,3] row_mask:0xf bank_mask:0x5
    s_waitcnt vmcnt(19)
    v_mfma_f32_16x16x32_bf16 v[20:23], v[240:243], v[12:15], 0
    v_mov_b32_dpp v24, v24 quad_perm:[0,0,0,0] row_mask:0xf bank_mask:0xf
    v_add_f32_dpp v24, v25, v24 quad_perm:[1,1,1,1] row_mask:0xf bank_mask:0xf
    s_waitcnt vmcnt(19)
    v_mfma_f32_16x16x32_bf16 v[20:23], v[244:247], v[16:19], v[20:23]
    v_add_f32_dpp v24, v26, v24 quad_perm:[2,2,2,2] row_mask:0xf bank_mask:0xf
    v_add_f32_dpp v46, v27, v24 quad_perm:[3,3,3,3] row_mask:0xf bank_mask:0xa
    v_max_f32 v34, v34, v46
    s_waitcnt vmcnt(17)
    v_mfma_f32_16x16x32_bf16 v[24:27], v[248:251], v[12:15], 0
    v_mov_b32_dpp v28, v28 quad_perm:[0,0,0,0] row_mask:0xf bank_mask:0xf
    v_add_f32_dpp v28, v29, v28 quad_perm:[1,1,1,1] row_mask:0xf bank_mask:0xf
    s_waitcnt vmcnt(17)
    v_mfma_f32_16x16x32_bf16 v[24:27], v[252:255], v[16:19], v[24:27]
    buffer_load_dwordx4 a[68:71], v1, s[4:7], s38 offen offset:2304 nt
    s_waitcnt vmcnt(4)
    v_add_f32_dpp v28, v30, v28 quad_perm:[2,2,2,2] row_mask:0xf bank_mask:0xf
    v_add_f32_dpp v47, v31, v28 quad_perm:[3,3,3,3] row_mask:0xf bank_mask:0x5
    s_waitcnt vmcnt(16)
    v_mfma_f32_16x16x32_bf16 v[28:31], a[0:3], v[12:15], 0
    v_mov_b32_dpp v20, v20 quad_perm:[0,0,0,0] row_mask:0xf bank_mask:0xf
    v_add_f32_dpp v20, v21, v20 quad_perm:[1,1,1,1] row_mask:0xf bank_mask:0xf
    s_waitcnt vmcnt(16)
    v_mfma_f32_16x16x32_bf16 v[28:31], a[4:7], v[16:19], v[28:31]
    v_add_f32_dpp v20, v22, v20 quad_perm:[2,2,2,2] row_mask:0xf bank_mask:0xf
    v_add_f32_dpp v47, v23, v20 quad_perm:[3,3,3,3] row_mask:0xf bank_mask:0xa
    v_max_f32 v34, v34, v47
    s_waitcnt vmcnt(14)
    v_mfma_f32_16x16x32_bf16 v[20:23], a[8:11], v[12:15], 0
    v_mov_b32_dpp v24, v24 quad_perm:[0,0,0,0] row_mask:0xf bank_mask:0xf
    v_add_f32_dpp v24, v25, v24 quad_perm:[1,1,1,1] row_mask:0xf bank_mask:0xf
    s_waitcnt vmcnt(14)
    v_mfma_f32_16x16x32_bf16 v[20:23], a[12:15], v[16:19], v[20:23]
    s_add_u32 s38, s28, 262144
    buffer_load_dwordx4 a[72:75], v1, s[4:7], s38 offen offset:0 nt
    s_waitcnt vmcnt(4)
    v_add_f32_dpp v24, v26, v24 quad_perm:[2,2,2,2] row_mask:0xf bank_mask:0xf
    v_add_f32_dpp v48, v27, v24 quad_perm:[3,3,3,3] row_mask:0xf bank_mask:0x5
    s_waitcnt vmcnt(13)
    v_mfma_f32_16x16x32_bf16 v[24:27], a[16:19], v[12:15], 0
    v_mov_b32_dpp v28, v28 quad_perm:[0,0,0,0] row_mask:0xf bank_mask:0xf
    v_add_f32_dpp v28, v29, v28 quad_perm:[1,1,1,1] row_mask:0xf bank_mask:0xf
    s_waitcnt vmcnt(13)
    v_mfma_f32_16x16x32_bf16 v[24:27], a[20:23], v[16:19], v[24:27]
    v_add_f32_dpp v28, v30, v28 quad_perm:[2,2,2,2] row_mask:0xf bank_mask:0xf
    v_add_f32_dpp v48, v31, v28 quad_perm:[3,3,3,3] row_mask:0xf bank_mask:0xa
    v_max_f32 v34, v34, v48
    s_waitcnt vmcnt(11)
    v_mfma_f32_16x16x32_bf16 v[28:31], a[24:27], v[12:15], 0
    v_mov_b32_dpp v20, v20 quad_perm:[0,0,0,0] row_mask:0xf bank_mask:0xf
    v_add_f32_dpp v20, v21, v20 quad_perm:[1,1,1,1] row_mask:0xf bank_mask:0xf
    s_waitcnt vmcnt(11)
    v_mfma_f32_16x16x32_bf16 v[28:31], a[28:31], v[16:19], v[28:31]
    buffer_load_dwordx4 a[76:79], v1, s[4:7], s38 offen offset:256 nt
    s_waitcnt vmcnt(4)
    v_add_f32_dpp v20, v22, v20 quad_perm:[2,2,2,2] row_mask:0xf bank_mask:0xf
    v_add_f32_dpp v49, v23, v20 quad_perm:[3,3,3,3] row_mask:0xf bank_mask:0x5
    s_waitcnt vmcnt(10)
    v_mfma_f32_16x16x32_bf16 v[20:23], a[32:35], v[12:15], 0
    v_mov_b32_dpp v24, v24 quad_perm:[0,0,0,0] row_mask:0xf bank_mask:0xf
    v_add_f32_dpp v24, v25, v24 quad_perm:[1,1,1,1] row_mask:0xf bank_mask:0xf
    s_waitcnt vmcnt(10)
    v_mfma_f32_16x16x32_bf16 v[20:23], a[36:39], v[16:19], v[20:23]
    v_add_f32_dpp v24, v26, v24 quad_perm:[2,2,2,2] row_mask:0xf bank_mask:0xf
    v_add_f32_dpp v49, v27, v24 quad_perm:[3,3,3,3] row_mask:0xf bank_mask:0xa
    v_max_f32 v34, v34, v49
    buffer_load_dwordx4 a[80:83], v1, s[4:7], s38 offen offset:2048 nt
    s_waitcnt vmcnt(4)
    buffer_load_dwordx4 a[84:87], v1, s[4:7], s38 offen offset:2304 nt
    s_waitcnt vmcnt(4)
    s_waitcnt vmcnt(10)
    v_mfma_f32_16x16x32_bf16 v[24:27], a[40:43], v[12:15], 0
    v_mov_b32_dpp v28, v28 quad_perm:[0,0,0,0] row_mask:0xf bank_mask:0xf
    v_add_f32_dpp v28, v29, v28 quad_perm:[1,1,1,1] row_mask:0xf bank_mask:0xf
    s_waitcnt vmcnt(10)
    v_mfma_f32_16x16x32_bf16 v[24:27], a[44:47], v[16:19], v[24:27]
    v_add_f32_dpp v28, v30, v28 quad_perm:[2,2,2,2] row_mask:0xf bank_mask:0xf
    v_add_f32_dpp v50, v31, v28 quad_perm:[3,3,3,3] row_mask:0xf bank_mask:0x5
    s_add_u32 s38, s28, 278528
    buffer_load_dwordx4 a[88:91], v1, s[4:7], s38 offen offset:0 nt
    s_waitcnt vmcnt(4)
    buffer_load_dwordx4 a[92:95], v1, s[4:7], s38 offen offset:256 nt
    s_waitcnt vmcnt(4)
    s_waitcnt vmcnt(10)
    v_mfma_f32_16x16x32_bf16 v[28:31], a[48:51], v[12:15], 0
    v_mov_b32_dpp v20, v20 quad_perm:[0,0,0,0] row_mask:0xf bank_mask:0xf
    v_add_f32_dpp v20, v21, v20 quad_perm:[1,1,1,1] row_mask:0xf bank_mask:0xf
    s_waitcnt vmcnt(10)
    v_mfma_f32_16x16x32_bf16 v[28:31], a[52:55], v[16:19], v[28:31]
    v_add_f32_dpp v20, v22, v20 quad_perm:[2,2,2,2] row_mask:0xf bank_mask:0xf
    v_add_f32_dpp v50, v23, v20 quad_perm:[3,3,3,3] row_mask:0xf bank_mask:0xa
    v_max_f32 v34, v34, v50
    buffer_load_dwordx4 a[96:99], v1, s[4:7], s38 offen offset:2048 nt
    s_waitcnt vmcnt(4)
    buffer_load_dwordx4 a[100:103], v1, s[4:7], s38 offen offset:2304 nt
    s_waitcnt vmcnt(4)
    s_waitcnt vmcnt(10)
    v_mfma_f32_16x16x32_bf16 v[20:23], a[56:59], v[12:15], 0
    v_mov_b32_dpp v24, v24 quad_perm:[0,0,0,0] row_mask:0xf bank_mask:0xf
    v_add_f32_dpp v24, v25, v24 quad_perm:[1,1,1,1] row_mask:0xf bank_mask:0xf
    s_waitcnt vmcnt(10)
    v_mfma_f32_16x16x32_bf16 v[20:23], a[60:63], v[16:19], v[20:23]
    v_add_f32_dpp v24, v26, v24 quad_perm:[2,2,2,2] row_mask:0xf bank_mask:0xf
    v_add_f32_dpp v51, v27, v24 quad_perm:[3,3,3,3] row_mask:0xf bank_mask:0x5
    s_add_u32 s38, s29, 0
    buffer_load_dwordx4 a[104:107], v1, s[4:7], s38 offen offset:0 nt
    s_waitcnt vmcnt(4)
    buffer_load_dwordx4 a[108:111], v1, s[4:7], s38 offen offset:256 nt
    s_waitcnt vmcnt(4)
    s_waitcnt vmcnt(10)
    v_mfma_f32_16x16x32_bf16 v[24:27], a[64:67], v[12:15], 0
    v_mov_b32_dpp v28, v28 quad_perm:[0,0,0,0] row_mask:0xf bank_mask:0xf
    v_add_f32_dpp v28, v29, v28 quad_perm:[1,1,1,1] row_mask:0xf bank_mask:0xf
    s_waitcnt vmcnt(10)
    v_mfma_f32_16x16x32_bf16 v[24:27], a[68:71], v[16:19], v[24:27]
    v_add_f32_dpp v28, v30, v28 quad_perm:[2,2,2,2] row_mask:0xf bank_mask:0xf
    v_add_f32_dpp v51, v31, v28 quad_perm:[3,3,3,3] row_mask:0xf bank_mask:0xa
    v_max_f32 v34, v34, v51
    s_add_u32 s38, s28, 0
    buffer_load_dwordx4 a[112:115], v2, s[8:11], s38 offen offset:0 nt
    s_waitcnt vmcnt(4)
    buffer_load_dwordx4 a[116:119], v2, s[8:11], s38 offen offset:256 nt
    s_waitcnt vmcnt(4)
    s_waitcnt vmcnt(10)
    v_mfma_f32_16x16x32_bf16 v[28:31], a[72:75], v[12:15], 0
    v_mov_b32_dpp v20, v20 quad_perm:[0,0,0,0] row_mask:0xf bank_mask:0xf
    v_add_f32_dpp v20, v21, v20 quad_perm:[1,1,1,1] row_mask:0xf bank_mask:0xf
    s_waitcnt vmcnt(10)
    v_mfma_f32_16x16x32_bf16 v[28:31], a[76:79], v[16:19], v[28:31]
    v_add_f32_dpp v20, v22, v20 quad_perm:[2,2,2,2] row_mask:0xf bank_mask:0xf
    v_add_f32_dpp v52, v23, v20 quad_perm:[3,3,3,3] row_mask:0xf bank_mask:0x5
    buffer_load_dwordx4 a[120:123], v2, s[8:11], s38 offen offset:2048 nt
    s_waitcnt vmcnt(4)
    buffer_load_dwordx4 a[124:127], v2, s[8:11], s38 offen offset:2304 nt
    s_waitcnt vmcnt(4)
    s_waitcnt vmcnt(10)
    v_mfma_f32_16x16x32_bf16 v[20:23], a[80:83], v[12:15], 0
    v_mov_b32_dpp v24, v24 quad_perm:[0,0,0,0] row_mask:0xf bank_mask:0xf
    v_add_f32_dpp v24, v25, v24 quad_perm:[1,1,1,1] row_mask:0xf bank_mask:0xf
    s_waitcnt vmcnt(10)
    v_mfma_f32_16x16x32_bf16 v[20:23], a[84:87], v[16:19], v[20:23]
    v_add_f32_dpp v24, v26, v24 quad_perm:[2,2,2,2] row_mask:0xf bank_mask:0xf
    v_add_f32_dpp v52, v27, v24 quad_perm:[3,3,3,3] row_mask:0xf bank_mask:0xa
    v_max_f32 v34, v34, v52
    s_add_u32 s38, s28, 16384
    buffer_load_dwordx4 a[128:131], v2, s[8:11], s38 offen offset:0 nt
    s_waitcnt vmcnt(4)
    buffer_load_dwordx4 a[132:135], v2, s[8:11], s38 offen offset:256 nt
    s_waitcnt vmcnt(10)
    v_mfma_f32_16x16x32_bf16 v[24:27], a[88:91], v[12:15], 0
    v_mov_b32_dpp v28, v28 quad_perm:[0,0,0,0] row_mask:0xf bank_mask:0xf
    v_add_f32_dpp v28, v29, v28 quad_perm:[1,1,1,1] row_mask:0xf bank_mask:0xf
    s_waitcnt vmcnt(10)
    v_mfma_f32_16x16x32_bf16 v[24:27], a[92:95], v[16:19], v[24:27]
    v_add_f32_dpp v28, v30, v28 quad_perm:[2,2,2,2] row_mask:0xf bank_mask:0xf
    v_add_f32_dpp v53, v31, v28 quad_perm:[3,3,3,3] row_mask:0xf bank_mask:0x5
    buffer_load_dwordx4 a[136:139], v2, s[8:11], s38 offen offset:2048 nt
    buffer_load_dwordx4 a[140:143], v2, s[8:11], s38 offen offset:2304 nt
    s_waitcnt vmcnt(10)
    v_mfma_f32_16x16x32_bf16 v[28:31], a[96:99], v[12:15], 0
    v_mov_b32_dpp v20, v20 quad_perm:[0,0,0,0] row_mask:0xf bank_mask:0xf
    v_add_f32_dpp v20, v21, v20 quad_perm:[1,1,1,1] row_mask:0xf bank_mask:0xf
    s_waitcnt vmcnt(10)
    v_mfma_f32_16x16x32_bf16 v[28:31], a[100:103], v[16:19], v[28:31]
    v_add_f32_dpp v20, v22, v20 quad_perm:[2,2,2,2] row_mask:0xf bank_mask:0xf
    v_add_f32_dpp v53, v23, v20 quad_perm:[3,3,3,3] row_mask:0xf bank_mask:0xa
    v_max_f32 v34, v34, v53
    s_add_u32 s38, s28, 32768
    buffer_load_dwordx4 a[144:147], v2, s[8:11], s38 offen offset:0 nt
    buffer_load_dwordx4 a[148:151], v2, s[8:11], s38 offen offset:256 nt
    s_waitcnt vmcnt(10)
    v_mfma_f32_16x16x32_bf16 v[20:23], a[104:107], v[12:15], 0
    v_mov_b32_dpp v24, v24 quad_perm:[0,0,0,0] row_mask:0xf bank_mask:0xf
    v_add_f32_dpp v24, v25, v24 quad_perm:[1,1,1,1] row_mask:0xf bank_mask:0xf
    s_waitcnt vmcnt(10)
    v_mfma_f32_16x16x32_bf16 v[20:23], a[108:111], v[16:19], v[20:23]
    v_add_f32_dpp v24, v26, v24 quad_perm:[2,2,2,2] row_mask:0xf bank_mask:0xf
    v_add_f32_dpp v54, v27, v24 quad_perm:[3,3,3,3] row_mask:0xf bank_mask:0x5
    v_mov_b32_dpp v28, v28 quad_perm:[0,0,0,0] row_mask:0xf bank_mask:0xf
    v_add_f32_dpp v28, v29, v28 quad_perm:[1,1,1,1] row_mask:0xf bank_mask:0xf
    v_add_f32_dpp v28, v30, v28 quad_perm:[2,2,2,2] row_mask:0xf bank_mask:0xf
    v_add_f32_dpp v54, v31, v28 quad_perm:[3,3,3,3] row_mask:0xf bank_mask:0xa
    v_max_f32 v34, v34, v54
    s_nop 1
    v_mov_b32_dpp v20, v20 quad_perm:[0,0,0,0] row_mask:0xf bank_mask:0xf
    v_add_f32_dpp v20, v21, v20 quad_perm:[1,1,1,1] row_mask:0xf bank_mask:0xf
    v_add_f32_dpp v20, v22, v20 quad_perm:[2,2,2,2] row_mask:0xf bank_mask:0xf
    v_add_f32 v20, s32, v20
    v_add_f32_dpp v55, v23, v20 quad_perm:[3,3,3,3] row_mask:0xf bank_mask:0x5
    v_max_f32 v34, v34, v55
    s_nop 1
    v_max_f32_dpp v34, v34, v34 row_half_mirror row_mask:0xf bank_mask:0xf
    v_mov_b32 v7, v34
    s_nop 1
    v_permlane32_swap_b32 v34, v7
    v_max_f32 v34, v34, v7
    v_mov_b32 v7, v34
    s_nop 1
    v_permlane16_swap_b32 v34, v7
    v_max_f32 v34, v34, v7
    v_mul_f32 v32, s36, v34
    v_mov_b32 v33, 0
    ds_write_b32 v4, v32
    v_fma_f32 v46, v46, s36, -v32
    v_exp_f32 v46, v46
    v_fma_f32 v47, v47, s36, -v32
    v_exp_f32 v47, v47
    v_add_f32 v33, v33, v46
    v_cvt_pk_bf16_f32 v28, v46, v46
    v_and_b32 v20, v28, v8
    v_and_b32 v21, v28, v9
    v_and_b32_dpp v22, v28, v10 row_shr:4 row_mask:0xf bank_mask:0xf bound_ctrl:0
    v_and_b32_dpp v23, v28, v11 row_shr:4 row_mask:0xf bank_mask:0xf bound_ctrl:0
    buffer_load_dwordx4 a[152:155], v2, s[8:11], s38 offen offset:2048 nt
    s_waitcnt vmcnt(63)
    ds_read_b128 v[56:59], v5 offset:0
    s_waitcnt vmcnt(63)
    ds_read_b128 v[60:63], v5 offset:1024
    s_waitcnt vmcnt(63)
    ds_read_b128 v[64:67], v5 offset:2048
    s_waitcnt vmcnt(63)
    ds_read_b128 v[68:71], v5 offset:3072
    v_and_b32 v26, v28, v10
    v_and_b32 v27, v28, v11
    s_waitcnt lgkmcnt(3)
    v_mfma_f32_16x16x32_bf16 v[12:15], v[20:23], v[56:59], 0
    s_waitcnt vmcnt(63)
    ds_read_b128 v[56:59], v5 offset:4096
    v_and_b32_dpp v24, v28, v8 row_shl:4 row_mask:0xf bank_mask:0xf bound_ctrl:0
    v_and_b32_dpp v25, v28, v9 row_shl:4 row_mask:0xf bank_mask:0xf bound_ctrl:0
    buffer_load_dwordx4 a[156:159], v2, s[8:11], s38 offen offset:2304 nt
    s_waitcnt lgkmcnt(3)
    v_mfma_f32_16x16x32_bf16 v[16:19], v[20:23], v[60:63], 0
    s_waitcnt vmcnt(63)
    ds_read_b128 v[60:63], v5 offset:5120
    v_add_f32 v33, v33, v47
    v_cvt_pk_bf16_f32 v29, v47, v47
    v_fma_f32 v48, v48, s36, -v32
    v_exp_f32 v48, v48
    s_waitcnt lgkmcnt(3)
    v_mfma_f32_16x16x32_bf16 v[12:15], v[24:27], v[64:67], v[12:15]
    s_waitcnt vmcnt(63)
    ds_read_b128 v[64:67], v5 offset:6144
    v_and_b32 v20, v29, v8
    v_and_b32 v21, v29, v9
    v_and_b32_dpp v22, v29, v10 row_shr:4 row_mask:0xf bank_mask:0xf bound_ctrl:0
    v_and_b32_dpp v23, v29, v11 row_shr:4 row_mask:0xf bank_mask:0xf bound_ctrl:0
    s_waitcnt lgkmcnt(3)
    v_mfma_f32_16x16x32_bf16 v[16:19], v[24:27], v[68:71], v[16:19]
    s_waitcnt vmcnt(63)
    ds_read_b128 v[68:71], v5 offset:7168
    s_add_u32 s38, s28, 49152
    buffer_load_dwordx4 a[160:163], v2, s[8:11], s38 offen offset:0 nt
    v_and_b32 v26, v29, v10
    v_and_b32 v27, v29, v11
    s_waitcnt lgkmcnt(3)
    v_mfma_f32_16x16x32_bf16 v[12:15], v[20:23], v[56:59], v[12:15]
    s_waitcnt vmcnt(63)
    ds_read_b128 v[56:59], v5 offset:8192
    v_and_b32_dpp v24, v29, v8 row_shl:4 row_mask:0xf bank_mask:0xf bound_ctrl:0
    v_and_b32_dpp v25, v29, v9 row_shl:4 row_mask:0xf bank_mask:0xf bound_ctrl:0
    s_waitcnt lgkmcnt(3)
    v_mfma_f32_16x16x32_bf16 v[16:19], v[20:23], v[60:63], v[16:19]
    s_waitcnt vmcnt(63)
    ds_read_b128 v[60:63], v5 offset:9216
    v_add_f32 v33, v33, v48
    v_cvt_pk_bf16_f32 v28, v48, v48
    v_fma_f32 v49, v49, s36, -v32
    v_exp_f32 v49, v49
    s_waitcnt lgkmcnt(3)
    v_mfma_f32_16x16x32_bf16 v[12:15], v[24:27], v[64:67], v[12:15]
    buffer_load_dwordx4 a[164:167], v2, s[8:11], s38 offen offset:256 nt
    s_waitcnt vmcnt(63)
    ds_read_b128 v[64:67], v5 offset:10240
    v_and_b32 v20, v28, v8
    v_and_b32 v21, v28, v9
    v_and_b32_dpp v22, v28, v10 row_shr:4 row_mask:0xf bank_mask:0xf bound_ctrl:0
    v_and_b32_dpp v23, v28, v11 row_shr:4 row_mask:0xf bank_mask:0xf bound_ctrl:0
    s_waitcnt lgkmcnt(3)
    v_mfma_f32_16x16x32_bf16 v[16:19], v[24:27], v[68:71], v[16:19]
    s_waitcnt vmcnt(63)
    ds_read_b128 v[68:71], v5 offset:11264
    v_and_b32 v26, v28, v10
    v_and_b32 v27, v28, v11
    s_waitcnt lgkmcnt(3)
    v_mfma_f32_16x16x32_bf16 v[12:15], v[20:23], v[56:59], v[12:15]
    s_waitcnt vmcnt(63)
    ds_read_b128 v[56:59], v5 offset:12288
    v_and_b32_dpp v24, v28, v8 row_shl:4 row_mask:0xf bank_mask:0xf bound_ctrl:0
    v_and_b32_dpp v25, v28, v9 row_shl:4 row_mask:0xf bank_mask:0xf bound_ctrl:0
    buffer_load_dwordx4 a[168:171], v2, s[8:11], s38 offen offset:2048 nt
    s_waitcnt lgkmcnt(3)
    v_mfma_f32_16x16x32_bf16 v[16:19], v[20:23], v[60:63], v[16:19]
    s_waitcnt vmcnt(63)
    ds_read_b128 v[60:63], v5 offset:13312
    v_add_f32 v33, v33, v49
    v_cvt_pk_bf16_f32 v29, v49, v49
    v_fma_f32 v50, v50, s36, -v32
    v_exp_f32 v50, v50
    s_waitcnt lgkmcnt(3)
    v_mfma_f32_16x16x32_bf16 v[12:15], v[24:27], v[64:67], v[12:15]
    s_waitcnt vmcnt(63)
    ds_read_b128 v[64:67], v5 offset:14336
    v_and_b32 v20, v29, v8
    v_and_b32 v21, v29, v9
    v_and_b32_dpp v22, v29, v10 row_shr:4 row_mask:0xf bank_mask:0xf bound_ctrl:0
    v_and_b32_dpp v23, v29, v11 row_shr:4 row_mask:0xf bank_mask:0xf bound_ctrl:0
    s_waitcnt lgkmcnt(3)
    v_mfma_f32_16x16x32_bf16 v[16:19], v[24:27], v[68:71], v[16:19]
    s_waitcnt vmcnt(63)
    ds_read_b128 v[68:71], v5 offset:15360
    buffer_load_dwordx4 a[172:175], v2, s[8:11], s38 offen offset:2304 nt
    v_and_b32 v26, v29, v10
    v_and_b32 v27, v29, v11
    s_waitcnt lgkmcnt(3)
    v_mfma_f32_16x16x32_bf16 v[12:15], v[20:23], v[56:59], v[12:15]
    s_waitcnt vmcnt(63)
    ds_read_b128 v[56:59], v5 offset:16384
    v_and_b32_dpp v24, v29, v8 row_shl:4 row_mask:0xf bank_mask:0xf bound_ctrl:0
    v_and_b32_dpp v25, v29, v9 row_shl:4 row_mask:0xf bank_mask:0xf bound_ctrl:0
    s_waitcnt lgkmcnt(3)
    v_mfma_f32_16x16x32_bf16 v[16:19], v[20:23], v[60:63], v[16:19]
    s_waitcnt vmcnt(63)
    ds_read_b128 v[60:63], v5 offset:17408
    v_add_f32 v33, v33, v50
    v_cvt_pk_bf16_f32 v28, v50, v50
    v_fma_f32 v51, v51, s36, -v32
    v_exp_f32 v51, v51
    s_waitcnt lgkmcnt(3)
    v_mfma_f32_16x16x32_bf16 v[12:15], v[24:27], v[64:67], v[12:15]
    s_add_u32 s38, s28, 65536
    buffer_load_dwordx4 a[176:179], v2, s[8:11], s38 offen offset:0 nt
    s_waitcnt vmcnt(63)
    ds_read_b128 v[64:67], v5 offset:18432
    v_and_b32 v20, v28, v8
    v_and_b32 v21, v28, v9
    v_and_b32_dpp v22, v28, v10 row_shr:4 row_mask:0xf bank_mask:0xf bound_ctrl:0
    v_and_b32_dpp v23, v28, v11 row_shr:4 row_mask:0xf bank_mask:0xf bound_ctrl:0
    s_waitcnt lgkmcnt(3)
    v_mfma_f32_16x16x32_bf16 v[16:19], v[24:27], v[68:71], v[16:19]
    s_waitcnt vmcnt(63)
    ds_read_b128 v[68:71], v5 offset:19456
    v_and_b32 v26, v28, v10
    v_and_b32 v27, v28, v11
    s_waitcnt lgkmcnt(3)
    v_mfma_f32_16x16x32_bf16 v[12:15], v[20:23], v[56:59], v[12:15]
    s_waitcnt vmcnt(63)
    ds_read_b128 v[56:59], v5 offset:20480
    v_and_b32_dpp v24, v28, v8 row_shl:4 row_mask:0xf bank_mask:0xf bound_ctrl:0
    v_and_b32_dpp v25, v28, v9 row_shl:4 row_mask:0xf bank_mask:0xf bound_ctrl:0
    buffer_load_dwordx4 a[180:183], v2, s[8:11], s38 offen offset:256 nt
    s_waitcnt lgkmcnt(3)
    v_mfma_f32_16x16x32_bf16 v[16:19], v[20:23], v[60:63], v[16:19]
    s_waitcnt vmcnt(63)
    ds_read_b128 v[60:63], v5 offset:21504
    v_add_f32 v33, v33, v51
    v_cvt_pk_bf16_f32 v29, v51, v51
    v_fma_f32 v52, v52, s36, -v32
    v_exp_f32 v52, v52
    s_waitcnt lgkmcnt(3)
    v_mfma_f32_16x16x32_bf16 v[12:15], v[24:27], v[64:67], v[12:15]
    s_waitcnt vmcnt(63)
    ds_read_b128 v[64:67], v5 offset:22528
    v_and_b32 v20, v29, v8
    v_and_b32 v21, v29, v9
    v_and_b32_dpp v22, v29, v10 row_shr:4 row_mask:0xf bank_mask:0xf bound_ctrl:0
    v_and_b32_dpp v23, v29, v11 row_shr:4 row_mask:0xf bank_mask:0xf bound_ctrl:0
    s_waitcnt lgkmcnt(3)
    v_mfma_f32_16x16x32_bf16 v[16:19], v[24:27], v[68:71], v[16:19]
    s_waitcnt vmcnt(63)
    ds_read_b128 v[68:71], v5 offset:23552
    buffer_load_dwordx4 a[184:187], v2, s[8:11], s38 offen offset:2048 nt
    v_and_b32 v26, v29, v10
    v_and_b32 v27, v29, v11
    s_waitcnt lgkmcnt(3)
    v_mfma_f32_16x16x32_bf16 v[12:15], v[20:23], v[56:59], v[12:15]
    s_waitcnt vmcnt(63)
    ds_read_b128 v[56:59], v5 offset:24576
    v_and_b32_dpp v24, v29, v8 row_shl:4 row_mask:0xf bank_mask:0xf bound_ctrl:0
    v_and_b32_dpp v25, v29, v9 row_shl:4 row_mask:0xf bank_mask:0xf bound_ctrl:0
    s_waitcnt lgkmcnt(3)
    v_mfma_f32_16x16x32_bf16 v[16:19], v[20:23], v[60:63], v[16:19]
    s_waitcnt vmcnt(63)
    ds_read_b128 v[60:63], v5 offset:25600
    v_add_f32 v33, v33, v52
    v_cvt_pk_bf16_f32 v28, v52, v52
    v_fma_f32 v53, v53, s36, -v32
    v_exp_f32 v53, v53
    s_waitcnt lgkmcnt(3)
    v_mfma_f32_16x16x32_bf16 v[12:15], v[24:27], v[64:67], v[12:15]
    buffer_load_dwordx4 a[188:191], v2, s[8:11], s38 offen offset:2304 nt
    s_waitcnt vmcnt(63)
    ds_read_b128 v[64:67], v5 offset:26624
    v_and_b32 v20, v28, v8
    v_and_b32 v21, v28, v9
    v_and_b32_dpp v22, v28, v10 row_shr:4 row_mask:0xf bank_mask:0xf bound_ctrl:0
    v_and_b32_dpp v23, v28, v11 row_shr:4 row_mask:0xf bank_mask:0xf bound_ctrl:0
    s_waitcnt lgkmcnt(3)
    v_mfma_f32_16x16x32_bf16 v[16:19], v[24:27], v[68:71], v[16:19]
    s_waitcnt vmcnt(63)
    ds_read_b128 v[68:71], v5 offset:27648
    v_and_b32 v26, v28, v10
    v_and_b32 v27, v28, v11
    s_waitcnt lgkmcnt(3)
    v_mfma_f32_16x16x32_bf16 v[12:15], v[20:23], v[56:59], v[12:15]
    s_waitcnt vmcnt(63)
    ds_read_b128 v[56:59], v5 offset:28672
    v_and_b32_dpp v24, v28, v8 row_shl:4 row_mask:0xf bank_mask:0xf bound_ctrl:0
    v_and_b32_dpp v25, v28, v9 row_shl:4 row_mask:0xf bank_mask:0xf bound_ctrl:0
    s_add_u32 s38, s28, 81920
    buffer_load_dwordx4 a[192:195], v2, s[8:11], s38 offen offset:0 nt
    s_waitcnt lgkmcnt(3)
    v_mfma_f32_16x16x32_bf16 v[16:19], v[20:23], v[60:63], v[16:19]
    s_waitcnt vmcnt(63)
    ds_read_b128 v[60:63], v5 offset:29696
    v_add_f32 v33, v33, v53
    v_cvt_pk_bf16_f32 v29, v53, v53
    v_fma_f32 v54, v54, s36, -v32
    v_exp_f32 v54, v54
    s_waitcnt lgkmcnt(3)
    v_mfma_f32_16x16x32_bf16 v[12:15], v[24:27], v[64:67], v[12:15]
    s_waitcnt vmcnt(63)
    ds_read_b128 v[64:67], v5 offset:30720
    v_and_b32 v20, v29, v8
    v_and_b32 v21, v29, v9
    v_and_b32_dpp v22, v29, v10 row_shr:4 row_mask:0xf bank_mask:0xf bound_ctrl:0
    v_and_b32_dpp v23, v29, v11 row_shr:4 row_mask:0xf bank_mask:0xf bound_ctrl:0
    s_waitcnt lgkmcnt(3)
    v_mfma_f32_16x16x32_bf16 v[16:19], v[24:27], v[68:71], v[16:19]
    s_waitcnt vmcnt(63)
    ds_read_b128 v[68:71], v5 offset:31744
    buffer_load_dwordx4 a[196:199], v2, s[8:11], s38 offen offset:256 nt
    v_and_b32 v26, v29, v10
    v_and_b32 v27, v29, v11
    s_waitcnt lgkmcnt(3)
    v_mfma_f32_16x16x32_bf16 v[12:15], v[20:23], v[56:59], v[12:15]
    s_waitcnt vmcnt(63)
    ds_read_b128 v[56:59], v5 offset:32768
    v_and_b32_dpp v24, v29, v8 row_shl:4 row_mask:0xf bank_mask:0xf bound_ctrl:0
    v_and_b32_dpp v25, v29, v9 row_shl:4 row_mask:0xf bank_mask:0xf bound_ctrl:0
    s_waitcnt lgkmcnt(3)
    v_mfma_f32_16x16x32_bf16 v[16:19], v[20:23], v[60:63], v[16:19]
    s_waitcnt vmcnt(63)
    ds_read_b128 v[60:63], v5 offset:33792
    v_add_f32 v33, v33, v54
    v_cvt_pk_bf16_f32 v28, v54, v54
    v_fma_f32 v55, v55, s36, -v32
    v_exp_f32 v55, v55
    s_waitcnt lgkmcnt(3)
    v_mfma_f32_16x16x32_bf16 v[12:15], v[24:27], v[64:67], v[12:15]
    buffer_load_dwordx4 a[200:203], v2, s[8:11], s38 offen offset:2048 nt
    s_waitcnt vmcnt(63)
    ds_read_b128 v[64:67], v5 offset:34816
    v_and_b32 v20, v28, v8
    v_and_b32 v21, v28, v9
    v_and_b32_dpp v22, v28, v10 row_shr:4 row_mask:0xf bank_mask:0xf bound_ctrl:0
    v_and_b32_dpp v23, v28, v11 row_shr:4 row_mask:0xf bank_mask:0xf bound_ctrl:0
    s_waitcnt lgkmcnt(3)
    v_mfma_f32_16x16x32_bf16 v[16:19], v[24:27], v[68:71], v[16:19]
    s_waitcnt vmcnt(63)
    ds_read_b128 v[68:71], v5 offset:35840
    v_and_b32 v26, v28, v10
    v_and_b32 v27, v28, v11
    s_waitcnt lgkmcnt(3)
    v_mfma_f32_16x16x32_bf16 v[12:15], v[20:23], v[56:59], v[12:15]
    s_waitcnt vmcnt(63)
    ds_read_b128 v[56:59], v5 offset:36864
    v_and_b32_dpp v24, v28, v8 row_shl:4 row_mask:0xf bank_mask:0xf bound_ctrl:0
    v_and_b32_dpp v25, v28, v9 row_shl:4 row_mask:0xf bank_mask:0xf bound_ctrl:0
    buffer_load_dwordx4 a[204:207], v2, s[8:11], s38 offen offset:2304 nt
    s_waitcnt lgkmcnt(3)
    v_mfma_f32_16x16x32_bf16 v[16:19], v[20:23], v[60:63], v[16:19]
    s_waitcnt vmcnt(63)
    ds_read_b128 v[60:63], v5 offset:37888
    v_add_f32 v33, v33, v55
    v_cvt_pk_bf16_f32 v29, v55, v55
    v_fma_f32 v37, v37, s36, -v32
    v_exp_f32 v37, v37
    s_waitcnt lgkmcnt(3)
    v_mfma_f32_16x16x32_bf16 v[12:15], v[24:27], v[64:67], v[12:15]
    v_and_b32 v20, v29, v8
    v_and_b32 v21, v29, v9
    v_and_b32_dpp v22, v29, v10 row_shr:4 row_mask:0xf bank_mask:0xf bound_ctrl:0
    v_and_b32_dpp v23, v29, v11 row_shr:4 row_mask:0xf bank_mask:0xf bound_ctrl:0
    s_waitcnt lgkmcnt(2)
    v_mfma_f32_16x16x32_bf16 v[16:19], v[24:27], v[68:71], v[16:19]
    v_add_f32 v33, v33, v37
    v_cvt_pk_bf16_f32 v28, v37, v37
    v_fma_f32 v38, v38, s36, -v32
    v_exp_f32 v38, v38
    s_waitcnt lgkmcnt(1)
    v_mfma_f32_16x16x32_bf16 v[12:15], v[20:23], v[56:59], v[12:15]
    s_add_u32 s38, s28, 98304
    buffer_load_dwordx4 a[208:211], v2, s[8:11], s38 offen offset:0 nt
    v_and_b32 v24, v28, v8
    v_and_b32 v25, v28, v9
    v_and_b32_dpp v26, v28, v10 row_shr:4 row_mask:0xf bank_mask:0xf bound_ctrl:0
    v_and_b32_dpp v27, v28, v11 row_shr:4 row_mask:0xf bank_mask:0xf bound_ctrl:0
    s_waitcnt lgkmcnt(0)
    v_mfma_f32_16x16x32_bf16 v[16:19], v[20:23], v[60:63], v[16:19]
    v_and_b32 v22, v28, v10
    v_and_b32 v23, v28, v11
    s_waitcnt vmcnt(23)
    v_mfma_f32_16x16x32_bf16 v[12:15], v[24:27], a[112:115], v[12:15]
    v_and_b32_dpp v20, v28, v8 row_shl:4 row_mask:0xf bank_mask:0xf bound_ctrl:0
    v_and_b32_dpp v21, v28, v9 row_shl:4 row_mask:0xf bank_mask:0xf bound_ctrl:0
    s_waitcnt vmcnt(23)
    v_mfma_f32_16x16x32_bf16 v[16:19], v[24:27], a[116:119], v[16:19]
    v_add_f32 v33, v33, v38
    v_cvt_pk_bf16_f32 v29, v38, v38
    v_fma_f32 v39, v39, s36, -v32
    v_exp_f32 v39, v39
    s_waitcnt vmcnt(21)
    v_mfma_f32_16x16x32_bf16 v[12:15], v[20:23], a[120:123], v[12:15]
    buffer_load_dwordx4 a[212:215], v2, s[8:11], s38 offen offset:256 nt
    v_and_b32 v24, v29, v8
    v_and_b32 v25, v29, v9
    v_and_b32_dpp v26, v29, v10 row_shr:4 row_mask:0xf bank_mask:0xf bound_ctrl:0
    v_and_b32_dpp v27, v29, v11 row_shr:4 row_mask:0xf bank_mask:0xf bound_ctrl:0
    s_waitcnt vmcnt(22)
    v_mfma_f32_16x16x32_bf16 v[16:19], v[20:23], a[124:127], v[16:19]
    v_and_b32 v22, v29, v10
    v_and_b32 v23, v29, v11
    s_waitcnt vmcnt(20)
    v_mfma_f32_16x16x32_bf16 v[12:15], v[24:27], a[128:131], v[12:15]
    v_and_b32_dpp v20, v29, v8 row_shl:4 row_mask:0xf bank_mask:0xf bound_ctrl:0
    v_and_b32_dpp v21, v29, v9 row_shl:4 row_mask:0xf bank_mask:0xf bound_ctrl:0
    s_waitcnt vmcnt(20)
    v_mfma_f32_16x16x32_bf16 v[16:19], v[24:27], a[132:135], v[16:19]
    v_add_f32 v33, v33, v39
    v_cvt_pk_bf16_f32 v28, v39, v39
    v_fma_f32 v40, v40, s36, -v32
    v_exp_f32 v40, v40
    s_waitcnt vmcnt(18)
    v_mfma_f32_16x16x32_bf16 v[12:15], v[20:23], a[136:139], v[12:15]
    buffer_load_dwordx4 a[216:219], v2, s[8:11], s38 offen offset:2048 nt
    v_and_b32 v24, v28, v8
    v_and_b32 v25, v28, v9
    v_and_b32_dpp v26, v28, v10 row_shr:4 row_mask:0xf bank_mask:0xf bound_ctrl:0
    v_and_b32_dpp v27, v28, v11 row_shr:4 row_mask:0xf bank_mask:0xf bound_ctrl:0
    s_waitcnt vmcnt(19)
    v_mfma_f32_16x16x32_bf16 v[16:19], v[20:23], a[140:143], v[16:19]
    v_and_b32 v22, v28, v10
    v_and_b32 v23, v28, v11
    s_waitcnt vmcnt(17)
    v_mfma_f32_16x16x32_bf16 v[12:15], v[24:27], a[144:147], v[12:15]
    v_and_b32_dpp v20, v28, v8 row_shl:4 row_mask:0xf bank_mask:0xf bound_ctrl:0
    v_and_b32_dpp v21, v28, v9 row_shl:4 row_mask:0xf bank_mask:0xf bound_ctrl:0
    s_waitcnt vmcnt(17)
    v_mfma_f32_16x16x32_bf16 v[16:19], v[24:27], a[148:151], v[16:19]
    v_add_f32 v33, v33, v40
    v_cvt_pk_bf16_f32 v29, v40, v40
    v_fma_f32 v41, v41, s36, -v32
    v_exp_f32 v41, v41
    s_waitcnt vmcnt(15)
    v_mfma_f32_16x16x32_bf16 v[12:15], v[20:23], a[152:155], v[12:15]
    buffer_load_dwordx4 a[220:223], v2, s[8:11], s38 offen offset:2304 nt
    v_and_b32 v24, v29, v8
    v_and_b32 v25, v29, v9
    v_and_b32_dpp v26, v29, v10 row_shr:4 row_mask:0xf bank_mask:0xf bound_ctrl:0
    v_and_b32_dpp v27, v29, v11 row_shr:4 row_mask:0xf bank_mask:0xf bound_ctrl:0
    s_waitcnt vmcnt(16)
    v_mfma_f32_16x16x32_bf16 v[16:19], v[20:23], a[156:159], v[16:19]
    v_and_b32 v22, v29, v10
    v_and_b32 v23, v29, v11
    s_waitcnt vmcnt(14)
    v_mfma_f32_16x16x32_bf16 v[12:15], v[24:27], a[160:163], v[12:15]
    v_and_b32_dpp v20, v29, v8 row_shl:4 row_mask:0xf bank_mask:0xf bound_ctrl:0
    v_and_b32_dpp v21, v29, v9 row_shl:4 row_mask:0xf bank_mask:0xf bound_ctrl:0
    s_waitcnt vmcnt(14)
    v_mfma_f32_16x16x32_bf16 v[16:19], v[24:27], a[164:167], v[16:19]
    v_add_f32 v33, v33, v41
    v_cvt_pk_bf16_f32 v28, v41, v41
    v_fma_f32 v42, v42, s36, -v32
    v_exp_f32 v42, v42
    s_waitcnt vmcnt(12)
    v_mfma_f32_16x16x32_bf16 v[12:15], v[20:23], a[168:171], v[12:15]
    s_add_u32 s38, s28, 114688
    buffer_load_dwordx4 a[224:227], v2, s[8:11], s38 offen offset:0 nt
    v_and_b32 v24, v28, v8
    v_and_b32 v25, v28, v9
    v_and_b32_dpp v26, v28, v10 row_shr:4 row_mask:0xf bank_mask:0xf bound_ctrl:0
    v_and_b32_dpp v27, v28, v11 row_shr:4 row_mask:0xf bank_mask:0xf bound_ctrl:0
    s_waitcnt vmcnt(13)
    v_mfma_f32_16x16x32_bf16 v[16:19], v[20:23], a[172:175], v[16:19]
    v_and_b32 v22, v28, v10
    v_and_b32 v23, v28, v11
    s_waitcnt vmcnt(11)
    v_mfma_f32_16x16x32_bf16 v[12:15], v[24:27], a[176:179], v[12:15]
    v_and_b32_dpp v20, v28, v8 row_shl:4 row_mask:0xf bank_mask:0xf bound_ctrl:0
    v_and_b32_dpp v21, v28, v9 row_shl:4 row_mask:0xf bank_mask:0xf bound_ctrl:0
    s_waitcnt vmcnt(11)
    v_mfma_f32_16x16x32_bf16 v[16:19], v[24:27], a[180:183], v[16:19]
    v_add_f32 v33, v33, v42
    v_cvt_pk_bf16_f32 v29, v42, v42
    v_fma_f32 v43, v43, s36, -v32
    v_exp_f32 v43, v43
    buffer_load_dwordx4 a[228:231], v2, s[8:11], s38 offen offset:256 nt
    s_waitcnt vmcnt(10)
    v_mfma_f32_16x16x32_bf16 v[12:15], v[20:23], a[184:187], v[12:15]
    v_and_b32 v24, v29, v8
    v_and_b32 v25, v29, v9
    v_and_b32_dpp v26, v29, v10 row_shr:4 row_mask:0xf bank_mask:0xf bound_ctrl:0
    v_and_b32_dpp v27, v29, v11 row_shr:4 row_mask:0xf bank_mask:0xf bound_ctrl:0
    s_waitcnt vmcnt(10)
    v_mfma_f32_16x16x32_bf16 v[16:19], v[20:23], a[188:191], v[16:19]
    v_and_b32 v22, v29, v10
    v_and_b32 v23, v29, v11
    buffer_load_dwordx4 a[232:235], v2, s[8:11], s38 offen offset:2048 nt
    buffer_load_dwordx4 a[236:239], v2, s[8:11], s38 offen offset:2304 nt
    s_waitcnt vmcnt(10)
    v_mfma_f32_16x16x32_bf16 v[12:15], v[24:27], a[192:195], v[12:15]
    v_and_b32_dpp v20, v29, v8 row_shl:4 row_mask:0xf bank_mask:0xf bound_ctrl:0
    v_and_b32_dpp v21, v29, v9 row_shl:4 row_mask:0xf bank_mask:0xf bound_ctrl:0
    s_waitcnt vmcnt(10)
    v_mfma_f32_16x16x32_bf16 v[16:19], v[24:27], a[196:199], v[16:19]
    v_add_f32 v33, v33, v43
    v_cvt_pk_bf16_f32 v28, v43, v43
    v_fma_f32 v44, v44, s36, -v32
    v_exp_f32 v44, v44
    s_add_u32 s38, s28, 131072
    buffer_load_dwordx4 a[240:243], v2, s[8:11], s38 offen offset:0 nt
    buffer_load_dwordx4 a[244:247], v2, s[8:11], s38 offen offset:256 nt
    s_waitcnt vmcnt(10)
    v_mfma_f32_16x16x32_bf16 v[12:15], v[20:23], a[200:203], v[12:15]
    v_and_b32 v24, v28, v8
    v_and_b32 v25, v28, v9
    v_and_b32_dpp v26, v28, v10 row_shr:4 row_mask:0xf bank_mask:0xf bound_ctrl:0
    v_and_b32_dpp v27, v28, v11 row_shr:4 row_mask:0xf bank_mask:0xf bound_ctrl:0
    s_waitcnt vmcnt(10)
    v_mfma_f32_16x16x32_bf16 v[16:19], v[20:23], a[204:207], v[16:19]
    v_and_b32 v22, v28, v10
    v_and_b32 v23, v28, v11
    buffer_load_dwordx4 a[248:251], v2, s[8:11], s38 offen offset:2048 nt
    buffer_load_dwordx4 a[252:255], v2, s[8:11], s38 offen offset:2304 nt
    s_waitcnt vmcnt(10)
    v_mfma_f32_16x16x32_bf16 v[12:15], v[24:27], a[208:211], v[12:15]
    v_and_b32_dpp v20, v28, v8 row_shl:4 row_mask:0xf bank_mask:0xf bound_ctrl:0
    v_and_b32_dpp v21, v28, v9 row_shl:4 row_mask:0xf bank_mask:0xf bound_ctrl:0
    s_waitcnt vmcnt(10)
    v_mfma_f32_16x16x32_bf16 v[16:19], v[24:27], a[212:215], v[16:19]
    v_add_f32 v33, v33, v44
    v_cvt_pk_bf16_f32 v29, v44, v44
    v_fma_f32 v45, v45, s36, -v32
    v_exp_f32 v45, v45
    s_max_u32 s41, s3, 1
    s_lshl_b32 s41, s41, 10
    s_add_u32 s41, s41, 154624
    v_lshl_add_u32 v36, v0, 4, s41
    s_waitcnt vmcnt(8)
    v_mfma_f32_16x16x32_bf16 v[12:15], v[20:23], a[216:219], v[12:15]
    v_and_b32 v24, v29, v8
    v_and_b32 v25, v29, v9
    v_and_b32_dpp v26, v29, v10 row_shr:4 row_mask:0xf bank_mask:0xf bound_ctrl:0
    v_and_b32_dpp v27, v29, v11 row_shr:4 row_mask:0xf bank_mask:0xf bound_ctrl:0
    s_waitcnt vmcnt(8)
    v_mfma_f32_16x16x32_bf16 v[16:19], v[20:23], a[220:223], v[16:19]
    v_add_u32 v7, s58, v3
    s_waitcnt lgkmcnt(0)
    s_barrier
    ds_read_b64 v[30:31], v3
    ds_read_b64 v[56:57], v3 offset:8
    ds_read_b32 v7, v7
    v_and_b32 v22, v29, v10
    v_and_b32 v23, v29, v11
    s_waitcnt vmcnt(6)
    v_mfma_f32_16x16x32_bf16 v[12:15], v[24:27], a[224:227], v[12:15]
    v_and_b32_dpp v20, v29, v8 row_shl:4 row_mask:0xf bank_mask:0xf bound_ctrl:0
    v_and_b32_dpp v21, v29, v9 row_shl:4 row_mask:0xf bank_mask:0xf bound_ctrl:0
    s_waitcnt vmcnt(6)
    v_mfma_f32_16x16x32_bf16 v[16:19], v[24:27], a[228:231], v[16:19]
    v_add_f32 v33, v33, v45
    v_cvt_pk_bf16_f32 v28, v45, v45
    v_and_b32 v24, v28, v8
    s_waitcnt vmcnt(4)
    v_mfma_f32_16x16x32_bf16 v[12:15], v[20:23], a[232:235], v[12:15]
    v_and_b32 v25, v28, v9
    v_and_b32_dpp v26, v28, v10 row_shr:4 row_mask:0xf bank_mask:0xf bound_ctrl:0
    v_and_b32_dpp v27, v28, v11 row_shr:4 row_mask:0xf bank_mask:0xf bound_ctrl:0
    s_waitcnt vmcnt(4)
    v_mfma_f32_16x16x32_bf16 v[16:19], v[20:23], a[236:239], v[16:19]
    v_and_b32 v22, v28, v10
    v_and_b32 v23, v28, v11
    v_and_b32_dpp v20, v28, v8 row_shl:4 row_mask:0xf bank_mask:0xf bound_ctrl:0
    v_and_b32_dpp v21, v28, v9 row_shl:4 row_mask:0xf bank_mask:0xf bound_ctrl:0
    s_waitcnt vmcnt(2)
    v_mfma_f32_16x16x32_bf16 v[12:15], v[24:27], a[240:243], v[12:15]
    s_waitcnt lgkmcnt(0)
    v_max3_f32 v34, v30, v31, v56
    v_max_f32 v34, v34, v57
    v_sub_f32 v30, v7, v34
    v_exp_f32 v30, v30
    s_waitcnt vmcnt(2)
    v_mfma_f32_16x16x32_bf16 v[16:19], v[24:27], a[244:247], v[16:19]
    s_nop 0
    s_waitcnt vmcnt(0)
    v_mfma_f32_16x16x32_bf16 v[12:15], v[20:23], a[248:251], v[12:15]
    s_waitcnt vmcnt(0)
    v_mfma_f32_16x16x32_bf16 v[16:19], v[20:23], a[252:255], v[16:19]
L_reduce:
    v_add_f32_dpp v33, v33, v33 row_half_mirror row_mask:0xf bank_mask:0xf
    v_mov_b32 v7, v33
    s_nop 1
    v_permlane32_swap_b32 v33, v7
    v_add_f32 v33, v33, v7
    v_mov_b32 v7, v33
    s_nop 1
    v_permlane16_swap_b32 v33, v7
    v_add_f32 v33, v33, v7
    v_mul_f32 v33, v33, v30
    s_mov_b32 exec_lo, 1
    s_mov_b32 exec_hi, 0x100
    ds_write_b32 v4, v33 offset:32
    s_mov_b64 exec, -1
    v_pk_mul_f32 v[12:13], v[12:13], v[30:31] op_sel_hi:[1,0]
    v_pk_mul_f32 v[14:15], v[14:15], v[30:31] op_sel_hi:[1,0]
    v_pk_mul_f32 v[16:17], v[16:17], v[30:31] op_sel_hi:[1,0]
    v_pk_mul_f32 v[18:19], v[18:19], v[30:31] op_sel_hi:[1,0]
    s_cmp_eq_u32 s3, 0
    s_cbranch_scc0 L_red_n0
    ds_write_b128 v36, v[16:19] offset:3072
    s_add_u32 s38, s45, 0
    s_cmp_eq_u32 s35, 1
    s_waitcnt lgkmcnt(0)
    s_barrier
    ds_read_b128 v[20:23], v36 offset:0
    ds_read_b128 v[24:27], v36 offset:1024
    ds_read_b128 v[56:59], v36 offset:2048
    s_waitcnt lgkmcnt(2)
    v_pk_add_f32 v[12:13], v[12:13], v[20:21]
    v_pk_add_f32 v[14:15], v[14:15], v[22:23]
    s_waitcnt lgkmcnt(1)
    v_pk_add_f32 v[12:13], v[12:13], v[24:25]
    v_pk_add_f32 v[14:15], v[14:15], v[26:27]
    s_waitcnt lgkmcnt(0)
    v_pk_add_f32 v[12:13], v[12:13], v[56:57]
    v_pk_add_f32 v[14:15], v[14:15], v[58:59]
    v_min_u32 v12, -2, v12
    v_min_u32 v13, -2, v13
    v_min_u32 v14, -2, v14
    v_min_u32 v15, -2, v15
    s_cbranch_scc0 L_far_10
    buffer_store_dwordx4 v[12:15], v35, s[20:23], s38 offen
    s_branch L_red_done
L_far_10:
    buffer_store_dwordx4 v[12:15], v35, s[20:23], s38 offen sc1
    s_branch L_red_done
L_red_1:
    ds_write_b128 v36, v[12:15] offset:0
    s_add_u32 s38, s45, 512
    s_cmp_eq_u32 s35, 1
    s_waitcnt lgkmcnt(0)
    s_barrier
    ds_read_b128 v[20:23], v36 offset:3072
    ds_read_b128 v[24:27], v36 offset:4096
    ds_read_b128 v[56:59], v36 offset:5120
    s_waitcnt lgkmcnt(2)
    v_pk_add_f32 v[16:17], v[16:17], v[20:21]
    v_pk_add_f32 v[18:19], v[18:19], v[22:23]
    s_waitcnt lgkmcnt(1)
    v_pk_add_f32 v[16:17], v[16:17], v[24:25]
    v_pk_add_f32 v[18:19], v[18:19], v[26:27]
    s_waitcnt lgkmcnt(0)
    v_pk_add_f32 v[16:17], v[16:17], v[56:57]
    v_pk_add_f32 v[18:19], v[18:19], v[58:59]
    v_min_u32 v16, -2, v16
    v_min_u32 v17, -2, v17
    v_min_u32 v18, -2, v18
    v_min_u32 v19, -2, v19
    s_cbranch_scc0 L_far_11
    buffer_store_dwordx4 v[16:19], v35, s[20:23], s38 offen
    s_branch L_red_done
L_far_11:
    buffer_store_dwordx4 v[16:19], v35, s[20:23], s38 offen sc1
    s_branch L_red_done
L_red_n0:
    s_cmp_eq_u32 s3, 1
    s_cbranch_scc1 L_red_1
    ds_write_b128 v36, v[12:15]
    ds_write_b128 v36, v[16:19] offset:3072
    v_lshrrev_b32 v7, 5, v0
    v_lshlrev_b32 v7, 12, v7
    v_min_u32 v24, -2, v34
    s_cmp_eq_u32 s3, 2
    s_waitcnt lgkmcnt(0)
    s_barrier
    s_cbranch_scc0 L_red_done
    ds_read_b128 v[20:23], v3 offset:32
    s_cmp_eq_u32 s35, 1
    s_waitcnt lgkmcnt(0)
    v_add_f32 v20, v20, v21
    v_add_f32 v22, v22, v23
    v_add_f32 v25, v20, v22
    v_min_u32 v25, -2, v25
    s_mov_b32 exec_lo, 1
    s_mov_b32 exec_hi, 1
    s_cbranch_scc0 L_ml_far
    buffer_store_dwordx2 v[24:25], v7, s[20:23], s46 offen
    s_branch L_ml_done
L_ml_far:
    buffer_store_dwordx2 v[24:25], v7, s[20:23], s46 offen sc1
L_ml_done:
    s_mov_b64 exec, -1
L_red_done:
    s_barrier
    s_add_u32 s44, s44, 8192
    s_add_u32 s45, s45, 458752
    s_add_u32 s46, s46, 65536
    s_add_u32 s42, s42, 1
    s_cmp_eq_u32 s42, 2
    s_cbranch_scc1 L_after2
    s_cmp_eq_u32 s42, 3
    s_cbranch_scc1 L_after3
    s_cmp_eq_u32 s42, 4
    s_cbranch_scc1 L_att_end
    s_cmp_lt_u32 s3, 2
    s_cbranch_scc1 L_clsk_12
    v_mov_b32 v20, -1
    v_mov_b32 v21, -1
    v_mov_b32 v22, -1
    v_mov_b32 v23, -1
    v_lshlrev_b32 v7, 4, v0
    s_sub_u32 s41, s3, 2
    s_lshl_b32 s47, s41, 12
    s_add_u32 s47, s47, s46
    s_add_u32 s47, s47, 65536
    s_mul_i32 s41, s41, 28672
    s_add_u32 s41, s41, s45
    s_add_u32 s41, s41, 458752
    s_cmp_eq_u32 s35, 1
    s_cbranch_scc0 L_clfar_13
    buffer_store_dwordx4 v[20:23], v7, s[20:23], s41 offen
    s_mov_b64 exec, 1
    buffer_store_dwordx2 v[20:21], v7, s[20:23], s47 offen
    s_mov_b64 exec, -1
    s_branch L_clsk_12
L_clfar_13:
    buffer_store_dwordx4 v[20:23], v7, s[20:23], s41 offen sc1
    s_mov_b64 exec, 1
    buffer_store_dwordx2 v[20:21], v7, s[20:23], s47 offen sc1
    s_mov_b64 exec, -1
L_clsk_12:
    s_nop 1
    buffer_load_dwordx4 v[44:47], v1, s[12:15], s52 offen offset:0
    buffer_load_dwordx4 v[48:51], v1, s[12:15], s52 offen offset:256
    buffer_load_dwordx4 v[52:55], v1, s[12:15], s52 offen offset:2048
    buffer_load_dwordx4 v[56:59], v1, s[12:15], s52 offen offset:2304
    buffer_load_dwordx4 v[60:63], v1, s[12:15], s53 offen offset:0
    buffer_load_dwordx4 v[64:67], v1, s[12:15], s53 offen offset:256
    buffer_load_dwordx4 v[68:71], v1, s[12:15], s53 offen offset:2048
    buffer_load_dwordx4 a[224:227], v1, s[12:15], s53 offen offset:2304
    buffer_load_dwordx4 a[228:231], v1, s[12:15], s54 offen offset:0
    buffer_load_dwordx4 a[232:235], v1, s[12:15], s54 offen offset:256
    buffer_load_dwordx4 a[236:239], v1, s[12:15], s54 offen offset:2048
    buffer_load_dwordx4 a[240:243], v1, s[12:15], s54 offen offset:2304
    buffer_load_dwordx4 a[244:247], v1, s[12:15], s55 offen offset:0
    buffer_load_dwordx4 a[248:251], v1, s[12:15], s55 offen offset:256
    buffer_load_dwordx4 a[252:255], v1, s[12:15], s55 offen offset:2048
    s_getpc_b64 s[38:39]
L_pc_14:
    s_add_u32 s38, s38, L_l2body-L_pc_14
    s_addc_u32 s39, s39, 0
    v_lshlrev_b32 v7, 6, v0
    global_load_dword v43, v7, s[38:39]
    v_add_u32 v7, 4096, v7
    global_load_dword v43, v7, s[38:39]
    v_mov_b32 v34, 4286578688
    v_lshlrev_b32 v42, 6, v0
    buffer_load_dword v43, v42, s[12:15], s55 offen offset:0
    s_mov_b32 exec_hi, 0
    buffer_load_dword v43, v42, s[12:15], s56 offen offset:0
    s_mov_b64 exec, -1
    s_mov_b32 exec_hi, 0
    buffer_load_dword v43, v42, s[12:15], s57 offen offset:0
    s_mov_b64 exec, -1
    buffer_load_dword v43, v42, s[16:19], s52 offen offset:0
    buffer_load_dword v43, v42, s[16:19], s53 offen offset:0
    buffer_load_dword v43, v42, s[16:19], s54 offen offset:0
    buffer_load_dword v43, v42, s[16:19], s55 offen offset:0
    buffer_load_dwordx4 v[12:15], v6, s[20:23], s44 offen sc1
    buffer_load_dwordx4 v[16:19], v6, s[20:23], s44 offen offset:256 sc1
    s_mov_b32 exec_hi, 0
    buffer_load_dword v43, v42, s[16:19], s56 offen offset:0
    s_mov_b64 exec, -1
    s_mov_b32 exec_hi, 0
    buffer_load_dword v43, v42, s[16:19], s57 offen offset:0
    s_mov_b64 exec, -1
    s_waitcnt vmcnt(2)
    v_max3_u32 v7, v12, v13, v14
    v_max3_u32 v7, v7, v15, v16
    v_max3_u32 v7, v7, v17, v18
    v_max_u32 v7, v7, v19
    v_cmp_eq_u32 vcc, -1, v7
    s_nop 0
    s_cmp_lg_u64 vcc, 0
    s_cbranch_scc1 L_qslow_15
    s_branch L_qok_16
L_qslow_15:
L_qpoll_17:
    s_cmp_eq_u32 s43, 0
    s_cbranch_scc1 L_qdone_18
    s_sub_u32 s43, s43, 1
    buffer_load_dwordx4 v[12:15], v6, s[20:23], s44 offen sc1
    buffer_load_dwordx4 v[16:19], v6, s[20:23], s44 offen offset:256 sc1
    s_waitcnt vmcnt(0)
    v_max3_u32 v7, v12, v13, v14
    v_max3_u32 v7, v7, v15, v16
    v_max3_u32 v7, v7, v17, v18
    v_max_u32 v7, v7, v19
    v_cmp_eq_u32 vcc, -1, v7
    s_nop 0
    s_cmp_lg_u64 vcc, 0
    s_cbranch_scc1 L_qpoll_17
L_qdone_18:
    s_nop 1
L_qok_16:
L_l2body:
    v_mfma_f32_16x16x32_bf16 v[20:23], v[44:47], v[12:15], 0
    buffer_load_dwordx4 v[44:47], v1, s[12:15], s55 offen offset:2304
    v_mfma_f32_16x16x32_bf16 v[20:23], v[48:51], v[16:19], v[20:23]
    buffer_load_dwordx4 v[48:51], v1, s[12:15], s56 offen offset:0
    v_mfma_f32_16x16x32_bf16 v[24:27], v[52:55], v[12:15], 0
    buffer_load_dwordx4 v[52:55], v1, s[12:15], s56 offen offset:256
    v_mfma_f32_16x16x32_bf16 v[24:27], v[56:59], v[16:19], v[24:27]
    buffer_load_dwordx4 v[56:59], v1, s[12:15], s57 offen offset:0
    v_mfma_f32_16x16x32_bf16 v[28:31], v[60:63], v[12:15], 0
    s_nop 4
    v_mov_b32_dpp v20, v20 quad_perm:[0,0,0,0] row_mask:0xf bank_mask:0xf
    buffer_load_dwordx4 v[60:63], v1, s[12:15], s57 offen offset:256
    v_mfma_f32_16x16x32_bf16 v[28:31], v[64:67], v[16:19], v[28:31]
    v_add_f32_dpp v20, v21, v20 quad_perm:[1,1,1,1] row_mask:0xf bank_mask:0xf
    v_add_f32_dpp v20, v22, v20 quad_perm:[2,2,2,2] row_mask:0xf bank_mask:0xf
    v_add_f32_dpp v37, v23, v20 quad_perm:[3,3,3,3] row_mask:0xf bank_mask:0x5
    buffer_load_dwordx4 v[64:67], v2, s[16:19], s52 offen offset:0
    v_mfma_f32_16x16x32_bf16 v[20:23], v[68:71], v[12:15], 0
    v_mov_b32_dpp v24, v24 quad_perm:[0,0,0,0] row_mask:0xf bank_mask:0xf
    v_add_f32_dpp v24, v25, v24 quad_perm:[1,1,1,1] row_mask:0xf bank_mask:0xf
    buffer_load_dwordx4 v[68:71], v2, s[16:19], s52 offen offset:256
    v_mfma_f32_16x16x32_bf16 v[20:23], a[224:227], v[16:19], v[20:23]
    v_add_f32_dpp v24, v26, v24 quad_perm:[2,2,2,2] row_mask:0xf bank_mask:0xf
    v_add_f32_dpp v37, v27, v24 quad_perm:[3,3,3,3] row_mask:0xf bank_mask:0xa
    v_max_f32 v34, v34, v37
    buffer_load_dwordx4 a[224:227], v2, s[16:19], s52 offen offset:2048
    v_mfma_f32_16x16x32_bf16 v[24:27], a[228:231], v[12:15], 0
    v_mov_b32_dpp v28, v28 quad_perm:[0,0,0,0] row_mask:0xf bank_mask:0xf
    v_add_f32_dpp v28, v29, v28 quad_perm:[1,1,1,1] row_mask:0xf bank_mask:0xf
    buffer_load_dwordx4 a[228:231], v2, s[16:19], s52 offen offset:2304
    v_mfma_f32_16x16x32_bf16 v[24:27], a[232:235], v[16:19], v[24:27]
    v_add_f32_dpp v28, v30, v28 quad_perm:[2,2,2,2] row_mask:0xf bank_mask:0xf
    v_add_f32_dpp v38, v31, v28 quad_perm:[3,3,3,3] row_mask:0xf bank_mask:0x5
    buffer_load_dwordx4 a[232:235], v2, s[16:19], s53 offen offset:0
    v_mfma_f32_16x16x32_bf16 v[28:31], a[236:239], v[12:15], 0
    v_mov_b32_dpp v20, v20 quad_perm:[0,0,0,0] row_mask:0xf bank_mask:0xf
    v_add_f32_dpp v20, v21, v20 quad_perm:[1,1,1,1] row_mask:0xf bank_mask:0xf
    buffer_load_dwordx4 a[236:239], v2, s[16:19], s53 offen offset:256
    v_mfma_f32_16x16x32_bf16 v[28:31], a[240:243], v[16:19], v[28:31]
    v_add_f32_dpp v20, v22, v20 quad_perm:[2,2,2,2] row_mask:0xf bank_mask:0xf
    v_add_f32_dpp v38, v23, v20 quad_perm:[3,3,3,3] row_mask:0xf bank_mask:0xa
    v_max_f32 v34, v34, v38
    buffer_load_dwordx4 a[240:243], v2, s[16:19], s53 offen offset:2048
    v_mfma_f32_16x16x32_bf16 v[20:23], a[244:247], v[12:15], 0
    v_mov_b32_dpp v24, v24 quad_perm:[0,0,0,0] row_mask:0xf bank_mask:0xf
    v_add_f32_dpp v24, v25, v24 quad_perm:[1,1,1,1] row_mask:0xf bank_mask:0xf
    buffer_load_dwordx4 a[244:247], v2, s[16:19], s53 offen offset:2304
    v_mfma_f32_16x16x32_bf16 v[20:23], a[248:251], v[16:19], v[20:23]
    v_add_f32_dpp v24, v26, v24 quad_perm:[2,2,2,2] row_mask:0xf bank_mask:0xf
    v_add_f32_dpp v39, v27, v24 quad_perm:[3,3,3,3] row_mask:0xf bank_mask:0x5
    buffer_load_dwordx4 a[248:251], v2, s[16:19], s54 offen offset:0
    v_mfma_f32_16x16x32_bf16 v[24:27], a[252:255], v[12:15], 0
    v_mov_b32_dpp v28, v28 quad_perm:[0,0,0,0] row_mask:0xf bank_mask:0xf
    v_add_f32_dpp v28, v29, v28 quad_perm:[1,1,1,1] row_mask:0xf bank_mask:0xf
    buffer_load_dwordx4 a[252:255], v2, s[16:19], s54 offen offset:256
    s_waitcnt vmcnt(14)
    v_mfma_f32_16x16x32_bf16 v[24:27], v[44:47], v[16:19], v[24:27]
    v_add_f32_dpp v28, v30, v28 quad_perm:[2,2,2,2] row_mask:0xf bank_mask:0xf
    v_add_f32_dpp v39, v31, v28 quad_perm:[3,3,3,3] row_mask:0xf bank_mask:0xa
    v_max_f32 v34, v34, v39
    buffer_load_dwordx4 v[44:47], v2, s[16:19], s54 offen offset:2048
    s_waitcnt vmcnt(14)
    v_mfma_f32_16x16x32_bf16 v[28:31], v[48:51], v[12:15], 0
    v_mov_b32_dpp v20, v20 quad_perm:[0,0,0,0] row_mask:0xf bank_mask:0xf
    v_add_f32_dpp v20, v21, v20 quad_perm:[1,1,1,1] row_mask:0xf bank_mask:0xf
    buffer_load_dwordx4 v[48:51], v2, s[16:19], s54 offen offset:2304
    s_waitcnt vmcnt(14)
    v_mfma_f32_16x16x32_bf16 v[28:31], v[52:55], v[16:19], v[28:31]
    v_add_f32_dpp v20, v22, v20 quad_perm:[2,2,2,2] row_mask:0xf bank_mask:0xf
    v_add_f32_dpp v40, v23, v20 quad_perm:[3,3,3,3] row_mask:0xf bank_mask:0x5
    buffer_load_dwordx4 v[52:55], v2, s[16:19], s55 offen offset:0
    s_waitcnt vmcnt(14)
    v_mfma_f32_16x16x32_bf16 v[20:23], v[56:59], v[12:15], 0
    v_mov_b32_dpp v24, v24 quad_perm:[0,0,0,0] row_mask:0xf bank_mask:0xf
    v_add_f32_dpp v24, v25, v24 quad_perm:[1,1,1,1] row_mask:0xf bank_mask:0xf
    buffer_load_dwordx4 v[56:59], v2, s[16:19], s55 offen offset:256
    s_waitcnt vmcnt(14)
    v_mfma_f32_16x16x32_bf16 v[20:23], v[60:63], v[16:19], v[20:23]
    v_add_f32_dpp v24, v26, v24 quad_perm:[2,2,2,2] row_mask:0xf bank_mask:0xf
    v_add_f32_dpp v40, v27, v24 quad_perm:[3,3,3,3] row_mask:0xf bank_mask:0xa
    v_max_f32 v34, v34, v40
    buffer_load_dwordx4 v[60:63], v2, s[16:19], s55 offen offset:2048
    v_mov_b32_dpp v28, v28 quad_perm:[0,0,0,0] row_mask:0xf bank_mask:0xf
    v_add_f32_dpp v28, v29, v28 quad_perm:[1,1,1,1] row_mask:0xf bank_mask:0xf
    v_add_f32_dpp v28, v30, v28 quad_perm:[2,2,2,2] row_mask:0xf bank_mask:0xf
    v_add_f32_dpp v41, v31, v28 quad_perm:[3,3,3,3] row_mask:0xf bank_mask:0x5
    s_nop 1
    v_mov_b32_dpp v20, v20 quad_perm:[0,0,0,0] row_mask:0xf bank_mask:0xf
    v_add_f32_dpp v20, v21, v20 quad_perm:[1,1,1,1] row_mask:0xf bank_mask:0xf
    v_add_f32_dpp v20, v22, v20 quad_perm:[2,2,2,2] row_mask:0xf bank_mask:0xf
    v_add_f32 v20, s33, v20
    v_add_f32_dpp v41, v23, v20 quad_perm:[3,3,3,3] row_mask:0xf bank_mask:0xa
    v_max_f32 v34, v34, v41
    s_nop 1
    v_max_f32_dpp v34, v34, v34 row_half_mirror row_mask:0xf bank_mask:0xf
    v_mov_b32 v7, v34
    s_nop 1
    v_permlane32_swap_b32 v34, v7
    v_max_f32 v34, v34, v7
    v_mov_b32 v7, v34
    s_nop 1
    v_permlane16_swap_b32 v34, v7
    v_max_f32 v34, v34, v7
    v_mul_f32 v32, s36, v34
    v_mov_b32 v33, 0
    ds_write_b32 v4, v32
    v_fma_f32 v37, v37, s36, -v32
    v_exp_f32 v37, v37
    v_fma_f32 v38, v38, s36, -v32
    v_exp_f32 v38, v38
    v_add_f32 v33, v33, v37
    v_cvt_pk_bf16_f32 v28, v37, v37
    v_and_b32 v20, v28, v8
    v_and_b32 v21, v28, v9
    v_and_b32_dpp v22, v28, v10 row_shr:4 row_mask:0xf bank_mask:0xf bound_ctrl:0
    v_and_b32_dpp v23, v28, v11 row_shr:4 row_mask:0xf bank_mask:0xf bound_ctrl:0
    v_and_b32 v26, v28, v10
    v_and_b32 v27, v28, v11
    s_waitcnt vmcnt(14)
    v_mfma_f32_16x16x32_bf16 v[12:15], v[20:23], v[64:67], 0
    buffer_load_dwordx4 v[64:67], v2, s[16:19], s55 offen offset:2304
    v_and_b32_dpp v24, v28, v8 row_shl:4 row_mask:0xf bank_mask:0xf bound_ctrl:0
    v_and_b32_dpp v25, v28, v9 row_shl:4 row_mask:0xf bank_mask:0xf bound_ctrl:0
    s_waitcnt vmcnt(14)
    v_mfma_f32_16x16x32_bf16 v[16:19], v[20:23], v[68:71], 0
    buffer_load_dwordx4 v[68:71], v2, s[16:19], s56 offen offset:0
    v_add_f32 v33, v33, v38
    v_cvt_pk_bf16_f32 v29, v38, v38
    v_fma_f32 v39, v39, s36, -v32
    v_exp_f32 v39, v39
    s_waitcnt vmcnt(14)
    v_mfma_f32_16x16x32_bf16 v[12:15], v[24:27], a[224:227], v[12:15]
    buffer_load_dwordx4 a[224:227], v2, s[16:19], s56 offen offset:256
    v_and_b32 v20, v29, v8
    v_and_b32 v21, v29, v9
    v_and_b32_dpp v22, v29, v10 row_shr:4 row_mask:0xf bank_mask:0xf bound_ctrl:0
    v_and_b32_dpp v23, v29, v11 row_shr:4 row_mask:0xf bank_mask:0xf bound_ctrl:0
    s_waitcnt vmcnt(14)
    v_mfma_f32_16x16x32_bf16 v[16:19], v[24:27], a[228:231], v[16:19]
    buffer_load_dwordx4 a[228:231], v2, s[16:19], s57 offen offset:0
    v_and_b32 v26, v29, v10
    v_and_b32 v27, v29, v11
    s_waitcnt vmcnt(14)
    v_mfma_f32_16x16x32_bf16 v[12:15], v[20:23], a[232:235], v[12:15]
    buffer_load_dwordx4 a[232:235], v2, s[16:19], s57 offen offset:256
    v_and_b32_dpp v24, v29, v8 row_shl:4 row_mask:0xf bank_mask:0xf bound_ctrl:0
    v_and_b32_dpp v25, v29, v9 row_shl:4 row_mask:0xf bank_mask:0xf bound_ctrl:0
    s_waitcnt vmcnt(14)
    v_mfma_f32_16x16x32_bf16 v[16:19], v[20:23], a[236:239], v[16:19]
    v_add_f32 v33, v33, v39
    v_cvt_pk_bf16_f32 v28, v39, v39
    v_fma_f32 v40, v40, s36, -v32
    v_exp_f32 v40, v40
    s_waitcnt vmcnt(13)
    v_mfma_f32_16x16x32_bf16 v[12:15], v[24:27], a[240:243], v[12:15]
    v_and_b32 v20, v28, v8
    v_and_b32 v21, v28, v9
    v_and_b32_dpp v22, v28, v10 row_shr:4 row_mask:0xf bank_mask:0xf bound_ctrl:0
    v_and_b32_dpp v23, v28, v11 row_shr:4 row_mask:0xf bank_mask:0xf bound_ctrl:0
    s_waitcnt vmcnt(12)
    v_mfma_f32_16x16x32_bf16 v[16:19], v[24:27], a[244:247], v[16:19]
    v_and_b32 v26, v28, v10
    v_and_b32 v27, v28, v11
    s_waitcnt vmcnt(11)
    v_mfma_f32_16x16x32_bf16 v[12:15], v[20:23], a[248:251], v[12:15]
    v_and_b32_dpp v24, v28, v8 row_shl:4 row_mask:0xf bank_mask:0xf bound_ctrl:0
    v_and_b32_dpp v25, v28, v9 row_shl:4 row_mask:0xf bank_mask:0xf bound_ctrl:0
    s_waitcnt vmcnt(10)
    v_mfma_f32_16x16x32_bf16 v[16:19], v[20:23], a[252:255], v[16:19]
    v_add_u32 v7, s58, v3
    s_waitcnt lgkmcnt(0)
    s_barrier
    ds_read_b64 v[30:31], v3
    ds_read_b64 v[42:43], v3 offset:8
    ds_read_b32 v7, v7
    v_add_f32 v33, v33, v40
    v_cvt_pk_bf16_f32 v29, v40, v40
    v_fma_f32 v41, v41, s36, -v32
    v_exp_f32 v41, v41
    s_waitcnt vmcnt(9)
    v_mfma_f32_16x16x32_bf16 v[12:15], v[24:27], v[44:47], v[12:15]
    v_and_b32 v20, v29, v8
    v_and_b32 v21, v29, v9
    v_and_b32_dpp v22, v29, v10 row_shr:4 row_mask:0xf bank_mask:0xf bound_ctrl:0
    v_and_b32_dpp v23, v29, v11 row_shr:4 row_mask:0xf bank_mask:0xf bound_ctrl:0
    s_waitcnt vmcnt(8)
    v_mfma_f32_16x16x32_bf16 v[16:19], v[24:27], v[48:51], v[16:19]
    v_and_b32 v26, v29, v10
    v_and_b32 v27, v29, v11
    s_waitcnt vmcnt(7)
    v_mfma_f32_16x16x32_bf16 v[12:15], v[20:23], v[52:55], v[12:15]
    v_and_b32_dpp v24, v29, v8 row_shl:4 row_mask:0xf bank_mask:0xf bound_ctrl:0
    v_and_b32_dpp v25, v29, v9 row_shl:4 row_mask:0xf bank_mask:0xf bound_ctrl:0
    s_waitcnt vmcnt(6)
    v_mfma_f32_16x16x32_bf16 v[16:19], v[20:23], v[56:59], v[16:19]
    v_add_f32 v33, v33, v41
    v_cvt_pk_bf16_f32 v28, v41, v41
    v_and_b32 v20, v28, v8
    v_and_b32 v21, v28, v9
    v_and_b32_dpp v22, v28, v10 row_shr:4 row_mask:0xf bank_mask:0xf bound_ctrl:0
    s_waitcnt vmcnt(5)
    v_mfma_f32_16x16x32_bf16 v[12:15], v[24:27], v[60:63], v[12:15]
    v_and_b32_dpp v23, v28, v11 row_shr:4 row_mask:0xf bank_mask:0xf bound_ctrl:0
    s_waitcnt lgkmcnt(0)
    v_max3_f32 v34, v30, v31, v42
    v_max_f32 v34, v34, v43
    v_sub_f32 v30, v7, v34
    v_exp_f32 v30, v30
    s_waitcnt vmcnt(4)
    v_mfma_f32_16x16x32_bf16 v[16:19], v[24:27], v[64:67], v[16:19]
    v_and_b32 v26, v28, v10
    v_and_b32 v27, v28, v11
    s_waitcnt vmcnt(3)
    v_mfma_f32_16x16x32_bf16 v[12:15], v[20:23], v[68:71], v[12:15]
    v_and_b32_dpp v24, v28, v8 row_shl:4 row_mask:0xf bank_mask:0xf bound_ctrl:0
    v_and_b32_dpp v25, v28, v9 row_shl:4 row_mask:0xf bank_mask:0xf bound_ctrl:0
    s_waitcnt vmcnt(2)
    v_mfma_f32_16x16x32_bf16 v[16:19], v[20:23], a[224:227], v[16:19]
    s_nop 0
    s_waitcnt vmcnt(1)
    v_mfma_f32_16x16x32_bf16 v[12:15], v[24:27], a[228:231], v[12:15]
    s_waitcnt vmcnt(0)
    v_mfma_f32_16x16x32_bf16 v[16:19], v[24:27], a[232:235], v[16:19]
    s_branch L_reduce
L_after2:
    s_cmp_lt_u32 s3, 2
    s_cbranch_scc1 L_clsk_19
    v_mov_b32 v20, -1
    v_mov_b32 v21, -1
    v_mov_b32 v22, -1
    v_mov_b32 v23, -1
    v_lshlrev_b32 v7, 4, v0
    s_sub_u32 s41, s3, 2
    s_lshl_b32 s47, s41, 12
    s_add_u32 s47, s47, s46
    s_add_u32 s47, s47, 65536
    s_mul_i32 s41, s41, 28672
    s_add_u32 s41, s41, s45
    s_add_u32 s41, s41, 458752
    s_cmp_eq_u32 s35, 1
    s_cbranch_scc0 L_clfar_20
    buffer_store_dwordx4 v[20:23], v7, s[20:23], s41 offen
    s_mov_b64 exec, 1
    buffer_store_dwordx2 v[20:21], v7, s[20:23], s47 offen
    s_mov_b64 exec, -1
    s_branch L_clsk_19
L_clfar_20:
    buffer_store_dwordx4 v[20:23], v7, s[20:23], s41 offen sc1
    s_mov_b64 exec, 1
    buffer_store_dwordx2 v[20:21], v7, s[20:23], s47 offen sc1
    s_mov_b64 exec, -1
L_clsk_19:
    s_nop 1
    v_mov_b32 v34, 4286578688
    v_mov_b32 v55, 4286578688
    s_add_u32 s38, s28, 114688
    buffer_load_dwordx4 a[224:227], v2, s[8:11], s38 offen offset:0 nt
    buffer_load_dwordx4 a[228:231], v2, s[8:11], s38 offen offset:256 nt
    buffer_load_dwordx4 a[232:235], v2, s[8:11], s38 offen offset:2048 nt
    buffer_load_dwordx4 a[236:239], v2, s[8:11], s38 offen offset:2304 nt
    s_add_u32 s38, s28, 131072
    buffer_load_dwordx4 a[240:243], v2, s[8:11], s38 offen offset:0 nt
    buffer_load_dwordx4 a[244:247], v2, s[8:11], s38 offen offset:256 nt
    buffer_load_dwordx4 a[248:251], v2, s[8:11], s38 offen offset:2048 nt
    buffer_load_dwordx4 a[252:255], v2, s[8:11], s38 offen offset:2304 nt
    s_getpc_b64 s[40:41]
L_pc_21:
    s_add_u32 s40, s40, L_l3_body-L_pc_21
    s_addc_u32 s41, s41, 0
    v_lshlrev_b32 v68, 6, v0
    global_load_dword v69, v68, s[40:41]
    v_add_u32 v68, 4096, v68
    v_min_u32 v68, 5056, v68
    global_load_dword v69, v68, s[40:41]
    buffer_load_dwordx4 v[12:15], v6, s[20:23], s44 offen sc1
    buffer_load_dwordx4 v[16:19], v6, s[20:23], s44 offen offset:256 sc1
    s_waitcnt vmcnt(0)
    v_max3_u32 v7, v12, v13, v14
    v_max3_u32 v7, v7, v15, v16
    v_max3_u32 v7, v7, v17, v18
    v_max_u32 v7, v7, v19
    v_cmp_eq_u32 vcc, -1, v7
    s_nop 0
    s_cmp_lg_u64 vcc, 0
    s_cbranch_scc1 L_qslow_22
    s_branch L_qok_23
L_qslow_22:
L_qpoll_24:
    s_cmp_eq_u32 s43, 0
    s_cbranch_scc1 L_qdone_25
    s_sub_u32 s43, s43, 1
    buffer_load_dwordx4 v[12:15], v6, s[20:23], s44 offen sc1
    buffer_load_dwordx4 v[16:19], v6, s[20:23], s44 offen offset:256 sc1
    s_waitcnt vmcnt(0)
    v_max3_u32 v7, v12, v13, v14
    v_max3_u32 v7, v7, v15, v16
    v_max3_u32 v7, v7, v17, v18
    v_max_u32 v7, v7, v19
    v_cmp_eq_u32 vcc, -1, v7
    s_nop 0
    s_cmp_lg_u64 vcc, 0
    s_cbranch_scc1 L_qpoll_24
L_qdone_25:
    s_nop 1
L_qok_23:
L_l3_body:
    v_mfma_f32_16x16x32_bf16 v[20:23], v[72:75], v[12:15], 0
    v_mfma_f32_16x16x32_bf16 v[20:23], v[76:79], v[16:19], v[20:23]
    v_mfma_f32_16x16x32_bf16 v[24:27], v[80:83], v[12:15], 0
    ds_read_b128 v[72:75], v5 offset:0
    v_mfma_f32_16x16x32_bf16 v[24:27], v[84:87], v[16:19], v[24:27]
    ds_read_b128 v[76:79], v5 offset:1024
    v_mfma_f32_16x16x32_bf16 v[28:31], v[88:91], v[12:15], 0
    ds_read_b128 v[80:83], v5 offset:2048
    s_nop 4
    v_mov_b32_dpp v20, v20 quad_perm:[0,0,0,0] row_mask:0xf bank_mask:0xf
    v_mfma_f32_16x16x32_bf16 v[28:31], v[92:95], v[16:19], v[28:31]
    ds_read_b128 v[84:87], v5 offset:3072
    v_add_f32_dpp v20, v21, v20 quad_perm:[1,1,1,1] row_mask:0xf bank_mask:0xf
    v_add_f32_dpp v20, v22, v20 quad_perm:[2,2,2,2] row_mask:0xf bank_mask:0xf
    v_add_f32_dpp v37, v23, v20 quad_perm:[3,3,3,3] row_mask:0xf bank_mask:0x5
    v_mfma_f32_16x16x32_bf16 v[20:23], v[96:99], v[12:15], 0
    ds_read_b128 v[88:91], v5 offset:4096
    v_mov_b32_dpp v24, v24 quad_perm:[0,0,0,0] row_mask:0xf bank_mask:0xf
    v_add_f32_dpp v24, v25, v24 quad_perm:[1,1,1,1] row_mask:0xf bank_mask:0xf
    v_mfma_f32_16x16x32_bf16 v[20:23], v[100:103], v[16:19], v[20:23]
    ds_read_b128 v[92:95], v5 offset:5120
    v_add_f32_dpp v24, v26, v24 quad_perm:[2,2,2,2] row_mask:0xf bank_mask:0xf
    v_add_f32_dpp v37, v27, v24 quad_perm:[3,3,3,3] row_mask:0xf bank_mask:0xa
    v_max_f32 v34, v34, v37
    v_mfma_f32_16x16x32_bf16 v[24:27], v[104:107], v[12:15], 0
    ds_read_b128 v[96:99], v5 offset:6144
    v_mov_b32_dpp v28, v28 quad_perm:[0,0,0,0] row_mask:0xf bank_mask:0xf
    v_add_f32_dpp v28, v29, v28 quad_perm:[1,1,1,1] row_mask:0xf bank_mask:0xf
    v_mfma_f32_16x16x32_bf16 v[24:27], v[108:111], v[16:19], v[24:27]
    s_waitcnt lgkmcnt(6)
    ds_read_b128 v[100:103], v5 offset:7168
    v_add_f32_dpp v28, v30, v28 quad_perm:[2,2,2,2] row_mask:0xf bank_mask:0xf
    v_add_f32_dpp v38, v31, v28 quad_perm:[3,3,3,3] row_mask:0xf bank_mask:0x5
    v_mfma_f32_16x16x32_bf16 v[28:31], v[112:115], v[12:15], 0
    ds_read_b128 v[104:107], v5 offset:8192
    v_mov_b32_dpp v20, v20 quad_perm:[0,0,0,0] row_mask:0xf bank_mask:0xf
    v_add_f32_dpp v20, v21, v20 quad_perm:[1,1,1,1] row_mask:0xf bank_mask:0xf
    v_mfma_f32_16x16x32_bf16 v[28:31], v[116:119], v[16:19], v[28:31]
    ds_read_b128 v[108:111], v5 offset:9216
    v_add_f32_dpp v20, v22, v20 quad_perm:[2,2,2,2] row_mask:0xf bank_mask:0xf
    v_add_f32_dpp v38, v23, v20 quad_perm:[3,3,3,3] row_mask:0xf bank_mask:0xa
    v_max_f32 v34, v34, v38
    v_mfma_f32_16x16x32_bf16 v[20:23], v[120:123], v[12:15], 0
    ds_read_b128 v[112:115], v5 offset:10240
    v_mov_b32_dpp v24, v24 quad_perm:[0,0,0,0] row_mask:0xf bank_mask:0xf
    v_add_f32_dpp v24, v25, v24 quad_perm:[1,1,1,1] row_mask:0xf bank_mask:0xf
    v_mfma_f32_16x16x32_bf16 v[20:23], v[124:127], v[16:19], v[20:23]
    ds_read_b128 v[116:119], v5 offset:11264
    v_add_f32_dpp v24, v26, v24 quad_perm:[2,2,2,2] row_mask:0xf bank_mask:0xf
    v_add_f32_dpp v39, v27, v24 quad_perm:[3,3,3,3] row_mask:0xf bank_mask:0x5
    v_mfma_f32_16x16x32_bf16 v[24:27], v[128:131], v[12:15], 0
    ds_read_b128 v[120:123], v5 offset:12288
    v_mov_b32_dpp v28, v28 quad_perm:[0,0,0,0] row_mask:0xf bank_mask:0xf
    v_add_f32_dpp v28, v29, v28 quad_perm:[1,1,1,1] row_mask:0xf bank_mask:0xf
    v_mfma_f32_16x16x32_bf16 v[24:27], v[132:135], v[16:19], v[24:27]
    ds_read_b128 v[124:127], v5 offset:13312
    v_add_f32_dpp v28, v30, v28 quad_perm:[2,2,2,2] row_mask:0xf bank_mask:0xf
    v_add_f32_dpp v39, v31, v28 quad_perm:[3,3,3,3] row_mask:0xf bank_mask:0xa
    v_max_f32 v34, v34, v39
    v_mfma_f32_16x16x32_bf16 v[28:31], v[136:139], v[12:15], 0
    ds_read_b128 v[128:131], v5 offset:14336
    v_mov_b32_dpp v20, v20 quad_perm:[0,0,0,0] row_mask:0xf bank_mask:0xf
    v_add_f32_dpp v20, v21, v20 quad_perm:[1,1,1,1] row_mask:0xf bank_mask:0xf
    v_mfma_f32_16x16x32_bf16 v[28:31], v[140:143], v[16:19], v[28:31]
    s_waitcnt lgkmcnt(6)
    ds_read_b128 v[132:135], v5 offset:15360
    v_add_f32_dpp v20, v22, v20 quad_perm:[2,2,2,2] row_mask:0xf bank_mask:0xf
    v_add_f32_dpp v40, v23, v20 quad_perm:[3,3,3,3] row_mask:0xf bank_mask:0x5
    v_mfma_f32_16x16x32_bf16 v[20:23], v[144:147], v[12:15], 0
    ds_read_b128 v[136:139], v5 offset:16384
    v_mov_b32_dpp v24, v24 quad_perm:[0,0,0,0] row_mask:0xf bank_mask:0xf
    v_add_f32_dpp v24, v25, v24 quad_perm:[1,1,1,1] row_mask:0xf bank_mask:0xf
    v_mfma_f32_16x16x32_bf16 v[20:23], v[148:151], v[16:19], v[20:23]
    ds_read_b128 v[140:143], v5 offset:17408
    v_add_f32_dpp v24, v26, v24 quad_perm:[2,2,2,2] row_mask:0xf bank_mask:0xf
    v_add_f32_dpp v40, v27, v24 quad_perm:[3,3,3,3] row_mask:0xf bank_mask:0xa
    v_max_f32 v34, v34, v40
    v_mfma_f32_16x16x32_bf16 v[24:27], v[152:155], v[12:15], 0
    ds_read_b128 v[144:147], v5 offset:18432
    v_mov_b32_dpp v28, v28 quad_perm:[0,0,0,0] row_mask:0xf bank_mask:0xf
    v_add_f32_dpp v28, v29, v28 quad_perm:[1,1,1,1] row_mask:0xf bank_mask:0xf
    v_mfma_f32_16x16x32_bf16 v[24:27], v[156:159], v[16:19], v[24:27]
    ds_read_b128 v[148:151], v5 offset:19456
    v_add_f32_dpp v28, v30, v28 quad_perm:[2,2,2,2] row_mask:0xf bank_mask:0xf
    v_add_f32_dpp v41, v31, v28 quad_perm:[3,3,3,3] row_mask:0xf bank_mask:0x5
    v_mfma_f32_16x16x32_bf16 v[28:31], v[160:163], v[12:15], 0
    ds_read_b128 v[152:155], v5 offset:20480
    v_mov_b32_dpp v20, v20 quad_perm:[0,0,0,0] row_mask:0xf bank_mask:0xf
    v_add_f32_dpp v20, v21, v20 quad_perm:[1,1,1,1] row_mask:0xf bank_mask:0xf
    v_mfma_f32_16x16x32_bf16 v[28:31], v[164:167], v[16:19], v[28:31]
    ds_read_b128 v[156:159], v5 offset:21504
    v_add_f32_dpp v20, v22, v20 quad_perm:[2,2,2,2] row_mask:0xf bank_mask:0xf
    v_add_f32_dpp v41, v23, v20 quad_perm:[3,3,3,3] row_mask:0xf bank_mask:0xa
    v_max_f32 v34, v34, v41
    v_mfma_f32_16x16x32_bf16 v[20:23], v[168:171], v[12:15], 0
    ds_read_b128 v[160:163], v5 offset:22528
    v_mov_b32_dpp v24, v24 quad_perm:[0,0,0,0] row_mask:0xf bank_mask:0xf
    v_add_f32_dpp v24, v25, v24 quad_perm:[1,1,1,1] row_mask:0xf bank_mask:0xf
    v_mfma_f32_16x16x32_bf16 v[20:23], v[172:175], v[16:19], v[20:23]
    s_waitcnt lgkmcnt(6)
    ds_read_b128 v[164:167], v5 offset:23552
    v_add_f32_dpp v24, v26, v24 quad_perm:[2,2,2,2] row_mask:0xf bank_mask:0xf
    v_add_f32_dpp v42, v27, v24 quad_perm:[3,3,3,3] row_mask:0xf bank_mask:0x5
    v_mfma_f32_16x16x32_bf16 v[24:27], v[176:179], v[12:15], 0
    ds_read_b128 v[168:171], v5 offset:24576
    v_mov_b32_dpp v28, v28 quad_perm:[0,0,0,0] row_mask:0xf bank_mask:0xf
    v_add_f32_dpp v28, v29, v28 quad_perm:[1,1,1,1] row_mask:0xf bank_mask:0xf
    v_mfma_f32_16x16x32_bf16 v[24:27], v[180:183], v[16:19], v[24:27]
    ds_read_b128 v[172:175], v5 offset:25600
    v_add_f32_dpp v28, v30, v28 quad_perm:[2,2,2,2] row_mask:0xf bank_mask:0xf
    v_add_f32_dpp v42, v31, v28 quad_perm:[3,3,3,3] row_mask:0xf bank_mask:0xa
    v_max_f32 v34, v34, v42
    v_mfma_f32_16x16x32_bf16 v[28:31], v[184:187], v[12:15], 0
    ds_read_b128 v[176:179], v5 offset:26624
    v_mov_b32_dpp v20, v20 quad_perm:[0,0,0,0] row_mask:0xf bank_mask:0xf
    v_add_f32_dpp v20, v21, v20 quad_perm:[1,1,1,1] row_mask:0xf bank_mask:0xf
    v_mfma_f32_16x16x32_bf16 v[28:31], v[188:191], v[16:19], v[28:31]
    ds_read_b128 v[180:183], v5 offset:27648
    v_add_f32_dpp v20, v22, v20 quad_perm:[2,2,2,2] row_mask:0xf bank_mask:0xf
    v_add_f32_dpp v43, v23, v20 quad_perm:[3,3,3,3] row_mask:0xf bank_mask:0x5
    v_mfma_f32_16x16x32_bf16 v[20:23], v[192:195], v[12:15], 0
    ds_read_b128 v[184:187], v5 offset:28672
    v_mov_b32_dpp v24, v24 quad_perm:[0,0,0,0] row_mask:0xf bank_mask:0xf
    v_add_f32_dpp v24, v25, v24 quad_perm:[1,1,1,1] row_mask:0xf bank_mask:0xf
    v_mfma_f32_16x16x32_bf16 v[20:23], v[196:199], v[16:19], v[20:23]
    ds_read_b128 v[188:191], v5 offset:29696
    v_add_f32_dpp v24, v26, v24 quad_perm:[2,2,2,2] row_mask:0xf bank_mask:0xf
    v_add_f32_dpp v43, v27, v24 quad_perm:[3,3,3,3] row_mask:0xf bank_mask:0xa
    v_max_f32 v34, v34, v43
    v_mfma_f32_16x16x32_bf16 v[24:27], v[200:203], v[12:15], 0
    ds_read_b128 v[192:195], v5 offset:30720
    v_mov_b32_dpp v28, v28 quad_perm:[0,0,0,0] row_mask:0xf bank_mask:0xf
    v_add_f32_dpp v28, v29, v28 quad_perm:[1,1,1,1] row_mask:0xf bank_mask:0xf
    v_mfma_f32_16x16x32_bf16 v[24:27], v[204:207], v[16:19], v[24:27]
    s_waitcnt lgkmcnt(6)
    ds_read_b128 v[196:199], v5 offset:31744
    v_add_f32_dpp v28, v30, v28 quad_perm:[2,2,2,2] row_mask:0xf bank_mask:0xf
    v_add_f32_dpp v44, v31, v28 quad_perm:[3,3,3,3] row_mask:0xf bank_mask:0x5
    v_mfma_f32_16x16x32_bf16 v[28:31], v[208:211], v[12:15], 0
    ds_read_b128 v[200:203], v5 offset:32768
    v_mov_b32_dpp v20, v20 quad_perm:[0,0,0,0] row_mask:0xf bank_mask:0xf
    v_add_f32_dpp v20, v21, v20 quad_perm:[1,1,1,1] row_mask:0xf bank_mask:0xf
    v_mfma_f32_16x16x32_bf16 v[28:31], v[212:215], v[16:19], v[28:31]
    ds_read_b128 v[204:207], v5 offset:33792
    v_add_f32_dpp v20, v22, v20 quad_perm:[2,2,2,2] row_mask:0xf bank_mask:0xf
    v_add_f32_dpp v44, v23, v20 quad_perm:[3,3,3,3] row_mask:0xf bank_mask:0xa
    v_max_f32 v34, v34, v44
    v_mfma_f32_16x16x32_bf16 v[20:23], v[216:219], v[12:15], 0
    ds_read_b128 v[208:211], v5 offset:34816
    v_mov_b32_dpp v24, v24 quad_perm:[0,0,0,0] row_mask:0xf bank_mask:0xf
    v_add_f32_dpp v24, v25, v24 quad_perm:[1,1,1,1] row_mask:0xf bank_mask:0xf
    v_mfma_f32_16x16x32_bf16 v[20:23], v[220:223], v[16:19], v[20:23]
    ds_read_b128 v[212:215], v5 offset:35840
    v_add_f32_dpp v24, v26, v24 quad_perm:[2,2,2,2] row_mask:0xf bank_mask:0xf
    v_add_f32_dpp v45, v27, v24 quad_perm:[3,3,3,3] row_mask:0xf bank_mask:0x5
    v_mfma_f32_16x16x32_bf16 v[24:27], v[224:227], v[12:15], 0
    ds_read_b128 v[216:219], v5 offset:36864
    v_mov_b32_dpp v28, v28 quad_perm:[0,0,0,0] row_mask:0xf bank_mask:0xf
    v_add_f32_dpp v28, v29, v28 quad_perm:[1,1,1,1] row_mask:0xf bank_mask:0xf
    v_mfma_f32_16x16x32_bf16 v[24:27], v[228:231], v[16:19], v[24:27]
    ds_read_b128 v[220:223], v5 offset:37888
    v_add_f32_dpp v28, v30, v28 quad_perm:[2,2,2,2] row_mask:0xf bank_mask:0xf
    v_add_f32_dpp v45, v31, v28 quad_perm:[3,3,3,3] row_mask:0xf bank_mask:0xa
    v_max_f32 v34, v34, v45
    v_mfma_f32_16x16x32_bf16 v[28:31], v[232:235], v[12:15], 0
    v_mov_b32_dpp v20, v20 quad_perm:[0,0,0,0] row_mask:0xf bank_mask:0xf
    v_add_f32_dpp v20, v21, v20 quad_perm:[1,1,1,1] row_mask:0xf bank_mask:0xf
    v_mfma_f32_16x16x32_bf16 v[28:31], v[236:239], v[16:19], v[28:31]
    v_add_f32_dpp v20, v22, v20 quad_perm:[2,2,2,2] row_mask:0xf bank_mask:0xf
    v_add_f32_dpp v46, v23, v20 quad_perm:[3,3,3,3] row_mask:0xf bank_mask:0x5
    v_mfma_f32_16x16x32_bf16 v[20:23], v[240:243], v[12:15], 0
    v_mov_b32_dpp v24, v24 quad_perm:[0,0,0,0] row_mask:0xf bank_mask:0xf
    v_add_f32_dpp v24, v25, v24 quad_perm:[1,1,1,1] row_mask:0xf bank_mask:0xf
    v_mfma_f32_16x16x32_bf16 v[20:23], v[244:247], v[16:19], v[20:23]
    v_add_f32_dpp v24, v26, v24 quad_perm:[2,2,2,2] row_mask:0xf bank_mask:0xf
    v_add_f32_dpp v46, v27, v24 quad_perm:[3,3,3,3] row_mask:0xf bank_mask:0xa
    v_max_f32 v34, v34, v46
    v_mfma_f32_16x16x32_bf16 v[24:27], v[248:251], v[12:15], 0
    v_mov_b32_dpp v28, v28 quad_perm:[0,0,0,0] row_mask:0xf bank_mask:0xf
    v_add_f32_dpp v28, v29, v28 quad_perm:[1,1,1,1] row_mask:0xf bank_mask:0xf
    v_mfma_f32_16x16x32_bf16 v[24:27], v[252:255], v[16:19], v[24:27]
    v_add_f32_dpp v28, v30, v28 quad_perm:[2,2,2,2] row_mask:0xf bank_mask:0xf
    v_add_f32_dpp v47, v31, v28 quad_perm:[3,3,3,3] row_mask:0xf bank_mask:0x5
    v_mfma_f32_16x16x32_bf16 v[28:31], a[0:3], v[12:15], 0
    v_mov_b32_dpp v20, v20 quad_perm:[0,0,0,0] row_mask:0xf bank_mask:0xf
    v_add_f32_dpp v20, v21, v20 quad_perm:[1,1,1,1] row_mask:0xf bank_mask:0xf
    v_mfma_f32_16x16x32_bf16 v[28:31], a[4:7], v[16:19], v[28:31]
    v_add_f32_dpp v20, v22, v20 quad_perm:[2,2,2,2] row_mask:0xf bank_mask:0xf
    v_add_f32_dpp v47, v23, v20 quad_perm:[3,3,3,3] row_mask:0xf bank_mask:0xa
    v_max_f32 v34, v34, v47
    v_mfma_f32_16x16x32_bf16 v[20:23], a[8:11], v[12:15], 0
    v_mov_b32_dpp v24, v24 quad_perm:[0,0,0,0] row_mask:0xf bank_mask:0xf
    v_add_f32_dpp v24, v25, v24 quad_perm:[1,1,1,1] row_mask:0xf bank_mask:0xf
    v_mfma_f32_16x16x32_bf16 v[20:23], a[12:15], v[16:19], v[20:23]
    v_add_f32_dpp v24, v26, v24 quad_perm:[2,2,2,2] row_mask:0xf bank_mask:0xf
    v_add_f32_dpp v48, v27, v24 quad_perm:[3,3,3,3] row_mask:0xf bank_mask:0x5
    v_mfma_f32_16x16x32_bf16 v[24:27], a[16:19], v[12:15], 0
    v_mov_b32_dpp v28, v28 quad_perm:[0,0,0,0] row_mask:0xf bank_mask:0xf
    v_add_f32_dpp v28, v29, v28 quad_perm:[1,1,1,1] row_mask:0xf bank_mask:0xf
    v_mfma_f32_16x16x32_bf16 v[24:27], a[20:23], v[16:19], v[24:27]
    v_add_f32_dpp v28, v30, v28 quad_perm:[2,2,2,2] row_mask:0xf bank_mask:0xf
    v_add_f32_dpp v48, v31, v28 quad_perm:[3,3,3,3] row_mask:0xf bank_mask:0xa
    v_max_f32 v34, v34, v48
    v_mfma_f32_16x16x32_bf16 v[28:31], a[24:27], v[12:15], 0
    v_mov_b32_dpp v20, v20 quad_perm:[0,0,0,0] row_mask:0xf bank_mask:0xf
    v_add_f32_dpp v20, v21, v20 quad_perm:[1,1,1,1] row_mask:0xf bank_mask:0xf
    v_mfma_f32_16x16x32_bf16 v[28:31], a[28:31], v[16:19], v[28:31]
    v_add_f32_dpp v20, v22, v20 quad_perm:[2,2,2,2] row_mask:0xf bank_mask:0xf
    v_add_f32_dpp v49, v23, v20 quad_perm:[3,3,3,3] row_mask:0xf bank_mask:0x5
    v_mfma_f32_16x16x32_bf16 v[20:23], a[32:35], v[12:15], 0
    v_mov_b32_dpp v24, v24 quad_perm:[0,0,0,0] row_mask:0xf bank_mask:0xf
    v_add_f32_dpp v24, v25, v24 quad_perm:[1,1,1,1] row_mask:0xf bank_mask:0xf
    v_mfma_f32_16x16x32_bf16 v[20:23], a[36:39], v[16:19], v[20:23]
    v_add_f32_dpp v24, v26, v24 quad_perm:[2,2,2,2] row_mask:0xf bank_mask:0xf
    v_add_f32_dpp v49, v27, v24 quad_perm:[3,3,3,3] row_mask:0xf bank_mask:0xa
    v_max_f32 v34, v34, v49
    v_mfma_f32_16x16x32_bf16 v[24:27], a[40:43], v[12:15], 0
    v_mov_b32_dpp v28, v28 quad_perm:[0,0,0,0] row_mask:0xf bank_mask:0xf
    v_add_f32_dpp v28, v29, v28 quad_perm:[1,1,1,1] row_mask:0xf bank_mask:0xf
    v_mfma_f32_16x16x32_bf16 v[24:27], a[44:47], v[16:19], v[24:27]
    v_add_f32_dpp v28, v30, v28 quad_perm:[2,2,2,2] row_mask:0xf bank_mask:0xf
    v_add_f32_dpp v50, v31, v28 quad_perm:[3,3,3,3] row_mask:0xf bank_mask:0x5
    v_mfma_f32_16x16x32_bf16 v[28:31], a[48:51], v[12:15], 0
    v_mov_b32_dpp v20, v20 quad_perm:[0,0,0,0] row_mask:0xf bank_mask:0xf
    v_add_f32_dpp v20, v21, v20 quad_perm:[1,1,1,1] row_mask:0xf bank_mask:0xf
    v_mfma_f32_16x16x32_bf16 v[28:31], a[52:55], v[16:19], v[28:31]
    v_add_f32_dpp v20, v22, v20 quad_perm:[2,2,2,2] row_mask:0xf bank_mask:0xf
    v_add_f32_dpp v50, v23, v20 quad_perm:[3,3,3,3] row_mask:0xf bank_mask:0xa
    v_max_f32 v34, v34, v50
    v_mfma_f32_16x16x32_bf16 v[20:23], a[56:59], v[12:15], 0
    v_mov_b32_dpp v24, v24 quad_perm:[0,0,0,0] row_mask:0xf bank_mask:0xf
    v_add_f32_dpp v24, v25, v24 quad_perm:[1,1,1,1] row_mask:0xf bank_mask:0xf
    v_mfma_f32_16x16x32_bf16 v[20:23], a[60:63], v[16:19], v[20:23]
    v_add_f32_dpp v24, v26, v24 quad_perm:[2,2,2,2] row_mask:0xf bank_mask:0xf
    v_add_f32_dpp v51, v27, v24 quad_perm:[3,3,3,3] row_mask:0xf bank_mask:0x5
    v_mfma_f32_16x16x32_bf16 v[24:27], a[64:67], v[12:15], 0
    v_mov_b32_dpp v28, v28 quad_perm:[0,0,0,0] row_mask:0xf bank_mask:0xf
    v_add_f32_dpp v28, v29, v28 quad_perm:[1,1,1,1] row_mask:0xf bank_mask:0xf
    v_mfma_f32_16x16x32_bf16 v[24:27], a[68:71], v[16:19], v[24:27]
    v_add_f32_dpp v28, v30, v28 quad_perm:[2,2,2,2] row_mask:0xf bank_mask:0xf
    v_add_f32_dpp v51, v31, v28 quad_perm:[3,3,3,3] row_mask:0xf bank_mask:0xa
    v_max_f32 v34, v34, v51
    v_mfma_f32_16x16x32_bf16 v[28:31], a[72:75], v[12:15], 0
    v_mov_b32_dpp v20, v20 quad_perm:[0,0,0,0] row_mask:0xf bank_mask:0xf
    v_add_f32_dpp v20, v21, v20 quad_perm:[1,1,1,1] row_mask:0xf bank_mask:0xf
    v_mfma_f32_16x16x32_bf16 v[28:31], a[76:79], v[16:19], v[28:31]
    v_add_f32_dpp v20, v22, v20 quad_perm:[2,2,2,2] row_mask:0xf bank_mask:0xf
    v_add_f32_dpp v52, v23, v20 quad_perm:[3,3,3,3] row_mask:0xf bank_mask:0x5
    v_mfma_f32_16x16x32_bf16 v[20:23], a[80:83], v[12:15], 0
    v_mov_b32_dpp v24, v24 quad_perm:[0,0,0,0] row_mask:0xf bank_mask:0xf
    v_add_f32_dpp v24, v25, v24 quad_perm:[1,1,1,1] row_mask:0xf bank_mask:0xf
    v_mfma_f32_16x16x32_bf16 v[20:23], a[84:87], v[16:19], v[20:23]
    v_add_f32_dpp v24, v26, v24 quad_perm:[2,2,2,2] row_mask:0xf bank_mask:0xf
    v_add_f32_dpp v52, v27, v24 quad_perm:[3,3,3,3] row_mask:0xf bank_mask:0xa
    v_max_f32 v34, v34, v52
    v_mfma_f32_16x16x32_bf16 v[24:27], a[88:91], v[12:15], 0
    v_mov_b32_dpp v28, v28 quad_perm:[0,0,0,0] row_mask:0xf bank_mask:0xf
    v_add_f32_dpp v28, v29, v28 quad_perm:[1,1,1,1] row_mask:0xf bank_mask:0xf
    v_mfma_f32_16x16x32_bf16 v[24:27], a[92:95], v[16:19], v[24:27]
    v_add_f32_dpp v28, v30, v28 quad_perm:[2,2,2,2] row_mask:0xf bank_mask:0xf
    v_add_f32_dpp v53, v31, v28 quad_perm:[3,3,3,3] row_mask:0xf bank_mask:0x5
    v_mfma_f32_16x16x32_bf16 v[28:31], a[96:99], v[12:15], 0
    v_mov_b32_dpp v20, v20 quad_perm:[0,0,0,0] row_mask:0xf bank_mask:0xf
    v_add_f32_dpp v20, v21, v20 quad_perm:[1,1,1,1] row_mask:0xf bank_mask:0xf
    v_mfma_f32_16x16x32_bf16 v[28:31], a[100:103], v[16:19], v[28:31]
    v_add_f32_dpp v20, v22, v20 quad_perm:[2,2,2,2] row_mask:0xf bank_mask:0xf
    v_add_f32_dpp v53, v23, v20 quad_perm:[3,3,3,3] row_mask:0xf bank_mask:0xa
    v_max_f32 v34, v34, v53
    v_mfma_f32_16x16x32_bf16 v[20:23], a[104:107], v[12:15], 0
    v_mov_b32_dpp v24, v24 quad_perm:[0,0,0,0] row_mask:0xf bank_mask:0xf
    v_add_f32_dpp v24, v25, v24 quad_perm:[1,1,1,1] row_mask:0xf bank_mask:0xf
    v_mfma_f32_16x16x32_bf16 v[20:23], a[108:111], v[16:19], v[20:23]
    v_add_f32_dpp v24, v26, v24 quad_perm:[2,2,2,2] row_mask:0xf bank_mask:0xf
    v_add_f32_dpp v54, v27, v24 quad_perm:[3,3,3,3] row_mask:0xf bank_mask:0x5
    v_mov_b32_dpp v28, v28 quad_perm:[0,0,0,0] row_mask:0xf bank_mask:0xf
    v_add_f32_dpp v28, v29, v28 quad_perm:[1,1,1,1] row_mask:0xf bank_mask:0xf
    v_add_f32_dpp v28, v30, v28 quad_perm:[2,2,2,2] row_mask:0xf bank_mask:0xf
    v_add_f32_dpp v54, v31, v28 quad_perm:[3,3,3,3] row_mask:0xf bank_mask:0xa
    v_max_f32 v34, v34, v54
    s_nop 1
    v_mov_b32_dpp v20, v20 quad_perm:[0,0,0,0] row_mask:0xf bank_mask:0xf
    v_add_f32_dpp v20, v21, v20 quad_perm:[1,1,1,1] row_mask:0xf bank_mask:0xf
    v_add_f32_dpp v20, v22, v20 quad_perm:[2,2,2,2] row_mask:0xf bank_mask:0xf
    v_add_f32 v20, s32, v20
    v_add_f32_dpp v55, v23, v20 quad_perm:[3,3,3,3] row_mask:0xf bank_mask:0x5
    v_max_f32 v34, v34, v55
    s_nop 1
    v_max_f32_dpp v34, v34, v34 row_half_mirror row_mask:0xf bank_mask:0xf
    v_mov_b32 v7, v34
    s_nop 1
    v_permlane32_swap_b32 v34, v7
    v_max_f32 v34, v34, v7
    v_mov_b32 v7, v34
    s_nop 1
    v_permlane16_swap_b32 v34, v7
    v_max_f32 v34, v34, v7
    v_mul_f32 v32, s36, v34
    v_mov_b32 v33, 0
    ds_write_b32 v4, v32
    v_fma_f32 v37, v37, s36, -v32
    v_exp_f32 v37, v37
    v_fma_f32 v38, v38, s36, -v32
    v_exp_f32 v38, v38
    v_add_f32 v33, v33, v37
    v_cvt_pk_bf16_f32 v28, v37, v37
    v_and_b32 v20, v28, v8
    v_and_b32 v21, v28, v9
    v_and_b32_dpp v22, v28, v10 row_shr:4 row_mask:0xf bank_mask:0xf bound_ctrl:0
    v_and_b32_dpp v23, v28, v11 row_shr:4 row_mask:0xf bank_mask:0xf bound_ctrl:0
    v_and_b32 v26, v28, v10
    v_and_b32 v27, v28, v11
    v_mfma_f32_16x16x32_bf16 v[12:15], v[20:23], a[112:115], 0
    v_and_b32_dpp v24, v28, v8 row_shl:4 row_mask:0xf bank_mask:0xf bound_ctrl:0
    v_and_b32_dpp v25, v28, v9 row_shl:4 row_mask:0xf bank_mask:0xf bound_ctrl:0
    v_mfma_f32_16x16x32_bf16 v[16:19], v[20:23], a[116:119], 0
    v_add_f32 v33, v33, v38
    v_cvt_pk_bf16_f32 v29, v38, v38
    v_fma_f32 v39, v39, s36, -v32
    v_exp_f32 v39, v39
    v_mfma_f32_16x16x32_bf16 v[12:15], v[24:27], a[120:123], v[12:15]
    v_and_b32 v20, v29, v8
    v_and_b32 v21, v29, v9
    v_and_b32_dpp v22, v29, v10 row_shr:4 row_mask:0xf bank_mask:0xf bound_ctrl:0
    v_and_b32_dpp v23, v29, v11 row_shr:4 row_mask:0xf bank_mask:0xf bound_ctrl:0
    v_mfma_f32_16x16x32_bf16 v[16:19], v[24:27], a[124:127], v[16:19]
    v_and_b32 v26, v29, v10
    v_and_b32 v27, v29, v11
    v_mfma_f32_16x16x32_bf16 v[12:15], v[20:23], a[128:131], v[12:15]
    v_and_b32_dpp v24, v29, v8 row_shl:4 row_mask:0xf bank_mask:0xf bound_ctrl:0
    v_and_b32_dpp v25, v29, v9 row_shl:4 row_mask:0xf bank_mask:0xf bound_ctrl:0
    v_mfma_f32_16x16x32_bf16 v[16:19], v[20:23], a[132:135], v[16:19]
    v_add_f32 v33, v33, v39
    v_cvt_pk_bf16_f32 v28, v39, v39
    v_fma_f32 v40, v40, s36, -v32
    v_exp_f32 v40, v40
    v_mfma_f32_16x16x32_bf16 v[12:15], v[24:27], a[136:139], v[12:15]
    v_and_b32 v20, v28, v8
    v_and_b32 v21, v28, v9
    v_and_b32_dpp v22, v28, v10 row_shr:4 row_mask:0xf bank_mask:0xf bound_ctrl:0
    v_and_b32_dpp v23, v28, v11 row_shr:4 row_mask:0xf bank_mask:0xf bound_ctrl:0
    v_mfma_f32_16x16x32_bf16 v[16:19], v[24:27], a[140:143], v[16:19]
    v_and_b32 v26, v28, v10
    v_and_b32 v27, v28, v11
    v_mfma_f32_16x16x32_bf16 v[12:15], v[20:23], a[144:147], v[12:15]
    v_and_b32_dpp v24, v28, v8 row_shl:4 row_mask:0xf bank_mask:0xf bound_ctrl:0
    v_and_b32_dpp v25, v28, v9 row_shl:4 row_mask:0xf bank_mask:0xf bound_ctrl:0
    v_mfma_f32_16x16x32_bf16 v[16:19], v[20:23], a[148:151], v[16:19]
    v_add_f32 v33, v33, v40
    v_cvt_pk_bf16_f32 v29, v40, v40
    v_fma_f32 v41, v41, s36, -v32
    v_exp_f32 v41, v41
    v_mfma_f32_16x16x32_bf16 v[12:15], v[24:27], a[152:155], v[12:15]
    v_and_b32 v20, v29, v8
    v_and_b32 v21, v29, v9
    v_and_b32_dpp v22, v29, v10 row_shr:4 row_mask:0xf bank_mask:0xf bound_ctrl:0
    v_and_b32_dpp v23, v29, v11 row_shr:4 row_mask:0xf bank_mask:0xf bound_ctrl:0
    v_mfma_f32_16x16x32_bf16 v[16:19], v[24:27], a[156:159], v[16:19]
    v_and_b32 v26, v29, v10
    v_and_b32 v27, v29, v11
    v_mfma_f32_16x16x32_bf16 v[12:15], v[20:23], a[160:163], v[12:15]
    v_and_b32_dpp v24, v29, v8 row_shl:4 row_mask:0xf bank_mask:0xf bound_ctrl:0
    v_and_b32_dpp v25, v29, v9 row_shl:4 row_mask:0xf bank_mask:0xf bound_ctrl:0
    v_mfma_f32_16x16x32_bf16 v[16:19], v[20:23], a[164:167], v[16:19]
    v_add_f32 v33, v33, v41
    v_cvt_pk_bf16_f32 v28, v41, v41
    v_fma_f32 v42, v42, s36, -v32
    v_exp_f32 v42, v42
    v_mfma_f32_16x16x32_bf16 v[12:15], v[24:27], a[168:171], v[12:15]
    v_and_b32 v20, v28, v8
    v_and_b32 v21, v28, v9
    v_and_b32_dpp v22, v28, v10 row_shr:4 row_mask:0xf bank_mask:0xf bound_ctrl:0
    v_and_b32_dpp v23, v28, v11 row_shr:4 row_mask:0xf bank_mask:0xf bound_ctrl:0
    v_mfma_f32_16x16x32_bf16 v[16:19], v[24:27], a[172:175], v[16:19]
    v_and_b32 v26, v28, v10
    v_and_b32 v27, v28, v11
    v_mfma_f32_16x16x32_bf16 v[12:15], v[20:23], a[176:179], v[12:15]
    v_and_b32_dpp v24, v28, v8 row_shl:4 row_mask:0xf bank_mask:0xf bound_ctrl:0
    v_and_b32_dpp v25, v28, v9 row_shl:4 row_mask:0xf bank_mask:0xf bound_ctrl:0
    v_mfma_f32_16x16x32_bf16 v[16:19], v[20:23], a[180:183], v[16:19]
    v_add_f32 v33, v33, v42
    v_cvt_pk_bf16_f32 v29, v42, v42
    v_fma_f32 v43, v43, s36, -v32
    v_exp_f32 v43, v43
    v_mfma_f32_16x16x32_bf16 v[12:15], v[24:27], a[184:187], v[12:15]
    v_and_b32 v20, v29, v8
    v_and_b32 v21, v29, v9
    v_and_b32_dpp v22, v29, v10 row_shr:4 row_mask:0xf bank_mask:0xf bound_ctrl:0
    v_and_b32_dpp v23, v29, v11 row_shr:4 row_mask:0xf bank_mask:0xf bound_ctrl:0
    v_mfma_f32_16x16x32_bf16 v[16:19], v[24:27], a[188:191], v[16:19]
    v_and_b32 v26, v29, v10
    v_and_b32 v27, v29, v11
    v_mfma_f32_16x16x32_bf16 v[12:15], v[20:23], a[192:195], v[12:15]
    v_and_b32_dpp v24, v29, v8 row_shl:4 row_mask:0xf bank_mask:0xf bound_ctrl:0
    v_and_b32_dpp v25, v29, v9 row_shl:4 row_mask:0xf bank_mask:0xf bound_ctrl:0
    v_mfma_f32_16x16x32_bf16 v[16:19], v[20:23], a[196:199], v[16:19]
    v_add_f32 v33, v33, v43
    v_cvt_pk_bf16_f32 v28, v43, v43
    v_fma_f32 v44, v44, s36, -v32
    v_exp_f32 v44, v44
    v_mfma_f32_16x16x32_bf16 v[12:15], v[24:27], a[200:203], v[12:15]
    v_and_b32 v20, v28, v8
    v_and_b32 v21, v28, v9
    v_and_b32_dpp v22, v28, v10 row_shr:4 row_mask:0xf bank_mask:0xf bound_ctrl:0
    v_and_b32_dpp v23, v28, v11 row_shr:4 row_mask:0xf bank_mask:0xf bound_ctrl:0
    v_mfma_f32_16x16x32_bf16 v[16:19], v[24:27], a[204:207], v[16:19]
    v_add_u32 v7, s58, v3
    s_waitcnt lgkmcnt(0)
    s_barrier
    ds_read_b64 v[30:31], v3
    ds_read_b64 v[56:57], v3 offset:8
    ds_read_b32 v7, v7
    v_and_b32 v26, v28, v10
    v_and_b32 v27, v28, v11
    v_mfma_f32_16x16x32_bf16 v[12:15], v[20:23], a[208:211], v[12:15]
    v_and_b32_dpp v24, v28, v8 row_shl:4 row_mask:0xf bank_mask:0xf bound_ctrl:0
    v_and_b32_dpp v25, v28, v9 row_shl:4 row_mask:0xf bank_mask:0xf bound_ctrl:0
    v_mfma_f32_16x16x32_bf16 v[16:19], v[20:23], a[212:215], v[16:19]
    v_add_f32 v33, v33, v44
    v_cvt_pk_bf16_f32 v29, v44, v44
    v_fma_f32 v45, v45, s36, -v32
    v_exp_f32 v45, v45
    v_mfma_f32_16x16x32_bf16 v[12:15], v[24:27], a[216:219], v[12:15]
    v_and_b32 v20, v29, v8
    v_and_b32 v21, v29, v9
    v_and_b32_dpp v22, v29, v10 row_shr:4 row_mask:0xf bank_mask:0xf bound_ctrl:0
    v_and_b32_dpp v23, v29, v11 row_shr:4 row_mask:0xf bank_mask:0xf bound_ctrl:0
    v_mfma_f32_16x16x32_bf16 v[16:19], v[24:27], a[220:223], v[16:19]
    v_and_b32 v26, v29, v10
    v_and_b32 v27, v29, v11
    v_and_b32_dpp v24, v29, v8 row_shl:4 row_mask:0xf bank_mask:0xf bound_ctrl:0
    v_and_b32_dpp v25, v29, v9 row_shl:4 row_mask:0xf bank_mask:0xf bound_ctrl:0
    v_mfma_f32_16x16x32_bf16 v[12:15], v[20:23], a[224:227], v[12:15]
    s_waitcnt lgkmcnt(0)
    v_max3_f32 v34, v30, v31, v56
    v_max_f32 v34, v34, v57
    v_sub_f32 v30, v7, v34
    v_exp_f32 v30, v30
    v_mfma_f32_16x16x32_bf16 v[16:19], v[20:23], a[228:231], v[16:19]
    v_add_f32 v33, v33, v45
    v_cvt_pk_bf16_f32 v28, v45, v45
    v_fma_f32 v46, v46, s36, -v32
    v_exp_f32 v46, v46
    v_mfma_f32_16x16x32_bf16 v[12:15], v[24:27], a[232:235], v[12:15]
    v_and_b32 v20, v28, v8
    v_and_b32 v21, v28, v9
    v_and_b32_dpp v22, v28, v10 row_shr:4 row_mask:0xf bank_mask:0xf bound_ctrl:0
    v_and_b32_dpp v23, v28, v11 row_shr:4 row_mask:0xf bank_mask:0xf bound_ctrl:0
    v_mfma_f32_16x16x32_bf16 v[16:19], v[24:27], a[236:239], v[16:19]
    v_and_b32 v26, v28, v10
    v_and_b32 v27, v28, v11
    v_mfma_f32_16x16x32_bf16 v[12:15], v[20:23], a[240:243], v[12:15]
    v_and_b32_dpp v24, v28, v8 row_shl:4 row_mask:0xf bank_mask:0xf bound_ctrl:0
    v_and_b32_dpp v25, v28, v9 row_shl:4 row_mask:0xf bank_mask:0xf bound_ctrl:0
    v_mfma_f32_16x16x32_bf16 v[16:19], v[20:23], a[244:247], v[16:19]
    v_add_f32 v33, v33, v46
    v_cvt_pk_bf16_f32 v29, v46, v46
    v_fma_f32 v47, v47, s36, -v32
    v_exp_f32 v47, v47
    v_mfma_f32_16x16x32_bf16 v[12:15], v[24:27], a[248:251], v[12:15]
    v_and_b32 v20, v29, v8
    v_and_b32 v21, v29, v9
    v_and_b32_dpp v22, v29, v10 row_shr:4 row_mask:0xf bank_mask:0xf bound_ctrl:0
    v_and_b32_dpp v23, v29, v11 row_shr:4 row_mask:0xf bank_mask:0xf bound_ctrl:0
    v_mfma_f32_16x16x32_bf16 v[16:19], v[24:27], a[252:255], v[16:19]
    v_and_b32 v26, v29, v10
    v_and_b32 v27, v29, v11
    v_mfma_f32_16x16x32_bf16 v[12:15], v[20:23], v[72:75], v[12:15]
    v_and_b32_dpp v24, v29, v8 row_shl:4 row_mask:0xf bank_mask:0xf bound_ctrl:0
    v_and_b32_dpp v25, v29, v9 row_shl:4 row_mask:0xf bank_mask:0xf bound_ctrl:0
    v_mfma_f32_16x16x32_bf16 v[16:19], v[20:23], v[76:79], v[16:19]
    v_add_f32 v33, v33, v47
    v_cvt_pk_bf16_f32 v28, v47, v47
    v_fma_f32 v48, v48, s36, -v32
    v_exp_f32 v48, v48
    v_mfma_f32_16x16x32_bf16 v[12:15], v[24:27], v[80:83], v[12:15]
    v_and_b32 v20, v28, v8
    v_and_b32 v21, v28, v9
    v_and_b32_dpp v22, v28, v10 row_shr:4 row_mask:0xf bank_mask:0xf bound_ctrl:0
    v_and_b32_dpp v23, v28, v11 row_shr:4 row_mask:0xf bank_mask:0xf bound_ctrl:0
    v_mfma_f32_16x16x32_bf16 v[16:19], v[24:27], v[84:87], v[16:19]
    v_and_b32 v26, v28, v10
    v_and_b32 v27, v28, v11
    v_mfma_f32_16x16x32_bf16 v[12:15], v[20:23], v[88:91], v[12:15]
    v_and_b32_dpp v24, v28, v8 row_shl:4 row_mask:0xf bank_mask:0xf bound_ctrl:0
    v_and_b32_dpp v25, v28, v9 row_shl:4 row_mask:0xf bank_mask:0xf bound_ctrl:0
    v_mfma_f32_16x16x32_bf16 v[16:19], v[20:23], v[92:95], v[16:19]
    v_add_f32 v33, v33, v48
    v_cvt_pk_bf16_f32 v29, v48, v48
    v_fma_f32 v49, v49, s36, -v32
    v_exp_f32 v49, v49
    v_mfma_f32_16x16x32_bf16 v[12:15], v[24:27], v[96:99], v[12:15]
    v_and_b32 v20, v29, v8
    v_and_b32 v21, v29, v9
    v_and_b32_dpp v22, v29, v10 row_shr:4 row_mask:0xf bank_mask:0xf bound_ctrl:0
    v_and_b32_dpp v23, v29, v11 row_shr:4 row_mask:0xf bank_mask:0xf bound_ctrl:0
    v_mfma_f32_16x16x32_bf16 v[16:19], v[24:27], v[100:103], v[16:19]
    v_and_b32 v26, v29, v10
    v_and_b32 v27, v29, v11
    v_mfma_f32_16x16x32_bf16 v[12:15], v[20:23], v[104:107], v[12:15]
    v_and_b32_dpp v24, v29, v8 row_shl:4 row_mask:0xf bank_mask:0xf bound_ctrl:0
    v_and_b32_dpp v25, v29, v9 row_shl:4 row_mask:0xf bank_mask:0xf bound_ctrl:0
    v_mfma_f32_16x16x32_bf16 v[16:19], v[20:23], v[108:111], v[16:19]
    v_add_f32 v33, v33, v49
    v_cvt_pk_bf16_f32 v28, v49, v49
    v_fma_f32 v50, v50, s36, -v32
    v_exp_f32 v50, v50
    v_mfma_f32_16x16x32_bf16 v[12:15], v[24:27], v[112:115], v[12:15]
    v_and_b32 v20, v28, v8
    v_and_b32 v21, v28, v9
    v_and_b32_dpp v22, v28, v10 row_shr:4 row_mask:0xf bank_mask:0xf bound_ctrl:0
    v_and_b32_dpp v23, v28, v11 row_shr:4 row_mask:0xf bank_mask:0xf bound_ctrl:0
    v_mfma_f32_16x16x32_bf16 v[16:19], v[24:27], v[116:119], v[16:19]
    v_and_b32 v26, v28, v10
    v_and_b32 v27, v28, v11
    v_mfma_f32_16x16x32_bf16 v[12:15], v[20:23], v[120:123], v[12:15]
    v_and_b32_dpp v24, v28, v8 row_shl:4 row_mask:0xf bank_mask:0xf bound_ctrl:0
    v_and_b32_dpp v25, v28, v9 row_shl:4 row_mask:0xf bank_mask:0xf bound_ctrl:0
    v_mfma_f32_16x16x32_bf16 v[16:19], v[20:23], v[124:127], v[16:19]
    v_add_f32 v33, v33, v50
    v_cvt_pk_bf16_f32 v29, v50, v50
    v_fma_f32 v51, v51, s36, -v32
    v_exp_f32 v51, v51
    v_mfma_f32_16x16x32_bf16 v[12:15], v[24:27], v[128:131], v[12:15]
    v_and_b32 v20, v29, v8
    v_and_b32 v21, v29, v9
    v_and_b32_dpp v22, v29, v10 row_shr:4 row_mask:0xf bank_mask:0xf bound_ctrl:0
    v_and_b32_dpp v23, v29, v11 row_shr:4 row_mask:0xf bank_mask:0xf bound_ctrl:0
    v_mfma_f32_16x16x32_bf16 v[16:19], v[24:27], v[132:135], v[16:19]
    v_and_b32 v26, v29, v10
    v_and_b32 v27, v29, v11
    v_mfma_f32_16x16x32_bf16 v[12:15], v[20:23], v[136:139], v[12:15]
    v_and_b32_dpp v24, v29, v8 row_shl:4 row_mask:0xf bank_mask:0xf bound_ctrl:0
    v_and_b32_dpp v25, v29, v9 row_shl:4 row_mask:0xf bank_mask:0xf bound_ctrl:0
    v_mfma_f32_16x16x32_bf16 v[16:19], v[20:23], v[140:143], v[16:19]
    v_add_f32 v33, v33, v51
    v_cvt_pk_bf16_f32 v28, v51, v51
    v_fma_f32 v52, v52, s36, -v32
    v_exp_f32 v52, v52
    v_mfma_f32_16x16x32_bf16 v[12:15], v[24:27], v[144:147], v[12:15]
    v_and_b32 v20, v28, v8
    v_and_b32 v21, v28, v9
    v_and_b32_dpp v22, v28, v10 row_shr:4 row_mask:0xf bank_mask:0xf bound_ctrl:0
    v_and_b32_dpp v23, v28, v11 row_shr:4 row_mask:0xf bank_mask:0xf bound_ctrl:0
    v_mfma_f32_16x16x32_bf16 v[16:19], v[24:27], v[148:151], v[16:19]
    v_and_b32 v26, v28, v10
    v_and_b32 v27, v28, v11
    v_mfma_f32_16x16x32_bf16 v[12:15], v[20:23], v[152:155], v[12:15]
    v_and_b32_dpp v24, v28, v8 row_shl:4 row_mask:0xf bank_mask:0xf bound_ctrl:0
    v_and_b32_dpp v25, v28, v9 row_shl:4 row_mask:0xf bank_mask:0xf bound_ctrl:0
    v_mfma_f32_16x16x32_bf16 v[16:19], v[20:23], v[156:159], v[16:19]
    v_add_f32 v33, v33, v52
    v_cvt_pk_bf16_f32 v29, v52, v52
    v_fma_f32 v53, v53, s36, -v32
    v_exp_f32 v53, v53
    v_mfma_f32_16x16x32_bf16 v[12:15], v[24:27], v[160:163], v[12:15]
    v_and_b32 v20, v29, v8
    v_and_b32 v21, v29, v9
    v_and_b32_dpp v22, v29, v10 row_shr:4 row_mask:0xf bank_mask:0xf bound_ctrl:0
    v_and_b32_dpp v23, v29, v11 row_shr:4 row_mask:0xf bank_mask:0xf bound_ctrl:0
    v_mfma_f32_16x16x32_bf16 v[16:19], v[24:27], v[164:167], v[16:19]
    v_and_b32 v26, v29, v10
    v_and_b32 v27, v29, v11
    v_mfma_f32_16x16x32_bf16 v[12:15], v[20:23], v[168:171], v[12:15]
    v_and_b32_dpp v24, v29, v8 row_shl:4 row_mask:0xf bank_mask:0xf bound_ctrl:0
    v_and_b32_dpp v25, v29, v9 row_shl:4 row_mask:0xf bank_mask:0xf bound_ctrl:0
    v_mfma_f32_16x16x32_bf16 v[16:19], v[20:23], v[172:175], v[16:19]
    v_add_f32 v33, v33, v53
    v_cvt_pk_bf16_f32 v28, v53, v53
    v_fma_f32 v54, v54, s36, -v32
    v_exp_f32 v54, v54
    v_mfma_f32_16x16x32_bf16 v[12:15], v[24:27], v[176:179], v[12:15]
    v_and_b32 v20, v28, v8
    v_and_b32 v21, v28, v9
    v_and_b32_dpp v22, v28, v10 row_shr:4 row_mask:0xf bank_mask:0xf bound_ctrl:0
    v_and_b32_dpp v23, v28, v11 row_shr:4 row_mask:0xf bank_mask:0xf bound_ctrl:0
    v_mfma_f32_16x16x32_bf16 v[16:19], v[24:27], v[180:183], v[16:19]
    v_and_b32 v26, v28, v10
    v_and_b32 v27, v28, v11
    v_mfma_f32_16x16x32_bf16 v[12:15], v[20:23], v[184:187], v[12:15]
    v_and_b32_dpp v24, v28, v8 row_shl:4 row_mask:0xf bank_mask:0xf bound_ctrl:0
    v_and_b32_dpp v25, v28, v9 row_shl:4 row_mask:0xf bank_mask:0xf bound_ctrl:0
    v_mfma_f32_16x16x32_bf16 v[16:19], v[20:23], v[188:191], v[16:19]
    v_add_f32 v33, v33, v54
    v_cvt_pk_bf16_f32 v29, v54, v54
    v_fma_f32 v55, v55, s36, -v32
    v_exp_f32 v55, v55
    v_mfma_f32_16x16x32_bf16 v[12:15], v[24:27], v[192:195], v[12:15]
    v_and_b32 v20, v29, v8
    v_and_b32 v21, v29, v9
    v_and_b32_dpp v22, v29, v10 row_shr:4 row_mask:0xf bank_mask:0xf bound_ctrl:0
    v_and_b32_dpp v23, v29, v11 row_shr:4 row_mask:0xf bank_mask:0xf bound_ctrl:0
    v_mfma_f32_16x16x32_bf16 v[16:19], v[24:27], v[196:199], v[16:19]
    v_and_b32 v26, v29, v10
    v_and_b32 v27, v29, v11
    v_mfma_f32_16x16x32_bf16 v[12:15], v[20:23], v[200:203], v[12:15]
    v_and_b32_dpp v24, v29, v8 row_shl:4 row_mask:0xf bank_mask:0xf bound_ctrl:0
    v_and_b32_dpp v25, v29, v9 row_shl:4 row_mask:0xf bank_mask:0xf bound_ctrl:0
    v_mfma_f32_16x16x32_bf16 v[16:19], v[20:23], v[204:207], v[16:19]
    v_add_f32 v33, v33, v55
    v_cvt_pk_bf16_f32 v28, v55, v55
    v_and_b32 v20, v28, v8
    v_mfma_f32_16x16x32_bf16 v[12:15], v[24:27], v[208:211], v[12:15]
    v_and_b32 v21, v28, v9
    v_and_b32_dpp v22, v28, v10 row_shr:4 row_mask:0xf bank_mask:0xf bound_ctrl:0
    v_and_b32_dpp v23, v28, v11 row_shr:4 row_mask:0xf bank_mask:0xf bound_ctrl:0
    v_mfma_f32_16x16x32_bf16 v[16:19], v[24:27], v[212:215], v[16:19]
    s_nop 0
    v_mfma_f32_16x16x32_bf16 v[12:15], v[20:23], v[216:219], v[12:15]
    v_mfma_f32_16x16x32_bf16 v[16:19], v[20:23], v[220:223], v[16:19]
    s_branch L_reduce
L_after3:
    v_mov_b32 v34, 4286578688
    s_add_u32 s38, s30, 0
    buffer_load_dwordx4 v[72:75], v1, s[12:15], s38 offen offset:0 nt
    buffer_load_dwordx4 v[76:79], v1, s[12:15], s38 offen offset:256 nt
    buffer_load_dwordx4 v[80:83], v1, s[12:15], s38 offen offset:2048 nt
    buffer_load_dwordx4 v[84:87], v1, s[12:15], s38 offen offset:2304 nt
    s_add_u32 s38, s30, 16384
    buffer_load_dwordx4 v[88:91], v1, s[12:15], s38 offen offset:0 nt
    buffer_load_dwordx4 v[92:95], v1, s[12:15], s38 offen offset:256 nt
    buffer_load_dwordx4 v[96:99], v1, s[12:15], s38 offen offset:2048 nt
    buffer_load_dwordx4 v[100:103], v1, s[12:15], s38 offen offset:2304 nt
    s_add_u32 s38, s30, 32768
    buffer_load_dwordx4 v[104:107], v1, s[12:15], s38 offen offset:0 nt
    buffer_load_dwordx4 v[108:111], v1, s[12:15], s38 offen offset:256 nt
    buffer_load_dwordx4 v[112:115], v1, s[12:15], s38 offen offset:2048 nt
    buffer_load_dwordx4 v[116:119], v1, s[12:15], s38 offen offset:2304 nt
    s_add_u32 s38, s30, 49152
    buffer_load_dwordx4 v[120:123], v1, s[12:15], s38 offen offset:0 nt
    buffer_load_dwordx4 v[124:127], v1, s[12:15], s38 offen offset:256 nt
    buffer_load_dwordx4 v[128:131], v1, s[12:15], s38 offen offset:2048 nt
    buffer_load_dwordx4 v[132:135], v1, s[12:15], s38 offen offset:2304 nt
    s_add_u32 s38, s50, 0
    buffer_load_dwordx4 v[136:139], v1, s[12:15], s38 offen offset:0 nt
    buffer_load_dwordx4 v[140:143], v1, s[12:15], s38 offen offset:256 nt
    s_add_u32 s38, s31, 0
    buffer_load_dwordx4 v[144:147], v1, s[12:15], s38 offen offset:0 nt
    buffer_load_dwordx4 v[148:151], v1, s[12:15], s38 offen offset:256 nt
    s_add_u32 s38, s30, 0
    buffer_load_dwordx4 v[152:155], v2, s[16:19], s38 offen offset:0 nt
    buffer_load_dwordx4 v[156:159], v2, s[16:19], s38 offen offset:256 nt
    buffer_load_dwordx4 v[160:163], v2, s[16:19], s38 offen offset:2048 nt
    buffer_load_dwordx4 v[164:167], v2, s[16:19], s38 offen offset:2304 nt
    s_add_u32 s38, s30, 16384
    buffer_load_dwordx4 v[168:171], v2, s[16:19], s38 offen offset:0 nt
    buffer_load_dwordx4 v[172:175], v2, s[16:19], s38 offen offset:256 nt
    buffer_load_dwordx4 v[176:179], v2, s[16:19], s38 offen offset:2048 nt
    buffer_load_dwordx4 v[180:183], v2, s[16:19], s38 offen offset:2304 nt
    s_add_u32 s38, s30, 32768
    buffer_load_dwordx4 v[184:187], v2, s[16:19], s38 offen offset:0 nt
    buffer_load_dwordx4 v[188:191], v2, s[16:19], s38 offen offset:256 nt
    buffer_load_dwordx4 v[192:195], v2, s[16:19], s38 offen offset:2048 nt
    buffer_load_dwordx4 v[196:199], v2, s[16:19], s38 offen offset:2304 nt
    s_add_u32 s38, s30, 49152
    buffer_load_dwordx4 v[200:203], v2, s[16:19], s38 offen offset:0 nt
    buffer_load_dwordx4 v[204:207], v2, s[16:19], s38 offen offset:256 nt
    buffer_load_dwordx4 v[208:211], v2, s[16:19], s38 offen offset:2048 nt
    buffer_load_dwordx4 v[212:215], v2, s[16:19], s38 offen offset:2304 nt
    s_add_u32 s38, s50, 0
    buffer_load_dwordx4 v[216:219], v2, s[16:19], s38 offen offset:0 nt
    buffer_load_dwordx4 v[220:223], v2, s[16:19], s38 offen offset:256 nt
    s_add_u32 s38, s31, 0
    buffer_load_dwordx4 v[224:227], v2, s[16:19], s38 offen offset:0 nt
    buffer_load_dwordx4 v[228:231], v2, s[16:19], s38 offen offset:256 nt
    s_getpc_b64 s[40:41]
L_pc_26:
    s_add_u32 s40, s40, L_l4_body-L_pc_26
    s_addc_u32 s41, s41, 0
    v_lshlrev_b32 v68, 6, v0
    v_min_u32 v68, 1472, v68
    global_load_dword v69, v68, s[40:41]
    buffer_load_dwordx4 v[12:15], v6, s[20:23], s44 offen sc1
    buffer_load_dwordx4 v[16:19], v6, s[20:23], s44 offen offset:256 sc1
    s_waitcnt vmcnt(0)
    v_max3_u32 v7, v12, v13, v14
    v_max3_u32 v7, v7, v15, v16
    v_max3_u32 v7, v7, v17, v18
    v_max_u32 v7, v7, v19
    v_cmp_eq_u32 vcc, -1, v7
    s_nop 0
    s_cmp_lg_u64 vcc, 0
    s_cbranch_scc1 L_qslow_27
    s_branch L_qok_28
L_qslow_27:
L_qpoll_29:
    s_cmp_eq_u32 s43, 0
    s_cbranch_scc1 L_qdone_30
    s_sub_u32 s43, s43, 1
    buffer_load_dwordx4 v[12:15], v6, s[20:23], s44 offen sc1
    buffer_load_dwordx4 v[16:19], v6, s[20:23], s44 offen offset:256 sc1
    s_waitcnt vmcnt(0)
    v_max3_u32 v7, v12, v13, v14
    v_max3_u32 v7, v7, v15, v16
    v_max3_u32 v7, v7, v17, v18
    v_max_u32 v7, v7, v19
    v_cmp_eq_u32 vcc, -1, v7
    s_nop 0
    s_cmp_lg_u64 vcc, 0
    s_cbranch_scc1 L_qpoll_29
L_qdone_30:
    s_nop 1
L_qok_28:
L_l4_body:
    v_mfma_f32_16x16x32_bf16 v[20:23], v[72:75], v[12:15], 0
    v_mfma_f32_16x16x32_bf16 v[20:23], v[76:79], v[16:19], v[20:23]
    v_mfma_f32_16x16x32_bf16 v[24:27], v[80:83], v[12:15], 0
    v_mfma_f32_16x16x32_bf16 v[24:27], v[84:87], v[16:19], v[24:27]
    v_mfma_f32_16x16x32_bf16 v[28:31], v[88:91], v[12:15], 0
    s_nop 4
    v_mov_b32_dpp v20, v20 quad_perm:[0,0,0,0] row_mask:0xf bank_mask:0xf
    v_mfma_f32_16x16x32_bf16 v[28:31], v[92:95], v[16:19], v[28:31]
    v_add_f32_dpp v20, v21, v20 quad_perm:[1,1,1,1] row_mask:0xf bank_mask:0xf
    v_add_f32_dpp v20, v22, v20 quad_perm:[2,2,2,2] row_mask:0xf bank_mask:0xf
    v_add_f32_dpp v37, v23, v20 quad_perm:[3,3,3,3] row_mask:0xf bank_mask:0x5
    v_mfma_f32_16x16x32_bf16 v[20:23], v[96:99], v[12:15], 0
    v_mov_b32_dpp v24, v24 quad_perm:[0,0,0,0] row_mask:0xf bank_mask:0xf
    v_add_f32_dpp v24, v25, v24 quad_perm:[1,1,1,1] row_mask:0xf bank_mask:0xf
    v_mfma_f32_16x16x32_bf16 v[20:23], v[100:103], v[16:19], v[20:23]
    v_add_f32_dpp v24, v26, v24 quad_perm:[2,2,2,2] row_mask:0xf bank_mask:0xf
    v_add_f32_dpp v37, v27, v24 quad_perm:[3,3,3,3] row_mask:0xf bank_mask:0xa
    v_max_f32 v34, v34, v37
    v_mfma_f32_16x16x32_bf16 v[24:27], v[104:107], v[12:15], 0
    v_mov_b32_dpp v28, v28 quad_perm:[0,0,0,0] row_mask:0xf bank_mask:0xf
    v_add_f32_dpp v28, v29, v28 quad_perm:[1,1,1,1] row_mask:0xf bank_mask:0xf
    v_mfma_f32_16x16x32_bf16 v[24:27], v[108:111], v[16:19], v[24:27]
    v_add_f32_dpp v28, v30, v28 quad_perm:[2,2,2,2] row_mask:0xf bank_mask:0xf
    v_add_f32_dpp v38, v31, v28 quad_perm:[3,3,3,3] row_mask:0xf bank_mask:0x5
    v_mfma_f32_16x16x32_bf16 v[28:31], v[112:115], v[12:15], 0
    v_mov_b32_dpp v20, v20 quad_perm:[0,0,0,0] row_mask:0xf bank_mask:0xf
    v_add_f32_dpp v20, v21, v20 quad_perm:[1,1,1,1] row_mask:0xf bank_mask:0xf
    v_mfma_f32_16x16x32_bf16 v[28:31], v[116:119], v[16:19], v[28:31]
    v_add_f32_dpp v20, v22, v20 quad_perm:[2,2,2,2] row_mask:0xf bank_mask:0xf
    v_add_f32_dpp v38, v23, v20 quad_perm:[3,3,3,3] row_mask:0xf bank_mask:0xa
    v_max_f32 v34, v34, v38
    v_mfma_f32_16x16x32_bf16 v[20:23], v[120:123], v[12:15], 0
    v_mov_b32_dpp v24, v24 quad_perm:[0,0,0,0] row_mask:0xf bank_mask:0xf
    v_add_f32_dpp v24, v25, v24 quad_perm:[1,1,1,1] row_mask:0xf bank_mask:0xf
    v_mfma_f32_16x16x32_bf16 v[20:23], v[124:127], v[16:19], v[20:23]
    v_add_f32_dpp v24, v26, v24 quad_perm:[2,2,2,2] row_mask:0xf bank_mask:0xf
    v_add_f32_dpp v39, v27, v24 quad_perm:[3,3,3,3] row_mask:0xf bank_mask:0x5
    v_mfma_f32_16x16x32_bf16 v[24:27], v[128:131], v[12:15], 0
    v_mov_b32_dpp v28, v28 quad_perm:[0,0,0,0] row_mask:0xf bank_mask:0xf
    v_add_f32_dpp v28, v29, v28 quad_perm:[1,1,1,1] row_mask:0xf bank_mask:0xf
    v_mfma_f32_16x16x32_bf16 v[24:27], v[132:135], v[16:19], v[24:27]
    v_add_f32_dpp v28, v30, v28 quad_perm:[2,2,2,2] row_mask:0xf bank_mask:0xf
    v_add_f32_dpp v39, v31, v28 quad_perm:[3,3,3,3] row_mask:0xf bank_mask:0xa
    v_max_f32 v34, v34, v39
    v_mfma_f32_16x16x32_bf16 v[28:31], v[136:139], v[12:15], 0
    v_mov_b32_dpp v20, v20 quad_perm:[0,0,0,0] row_mask:0xf bank_mask:0xf
    v_add_f32_dpp v20, v21, v20 quad_perm:[1,1,1,1] row_mask:0xf bank_mask:0xf
    v_mfma_f32_16x16x32_bf16 v[28:31], v[140:143], v[16:19], v[28:31]
    v_add_f32_dpp v20, v22, v20 quad_perm:[2,2,2,2] row_mask:0xf bank_mask:0xf
    v_add_f32_dpp v40, v23, v20 quad_perm:[3,3,3,3] row_mask:0xf bank_mask:0x5
    v_mfma_f32_16x16x32_bf16 v[20:23], v[144:147], v[12:15], 0
    v_mov_b32_dpp v24, v24 quad_perm:[0,0,0,0] row_mask:0xf bank_mask:0xf
    v_add_f32_dpp v24, v25, v24 quad_perm:[1,1,1,1] row_mask:0xf bank_mask:0xf
    v_mfma_f32_16x16x32_bf16 v[20:23], v[148:151], v[16:19], v[20:23]
    v_add_f32_dpp v24, v26, v24 quad_perm:[2,2,2,2] row_mask:0xf bank_mask:0xf
    v_add_f32_dpp v40, v27, v24 quad_perm:[3,3,3,3] row_mask:0xf bank_mask:0xa
    v_max_f32 v34, v34, v40
    v_mov_b32_dpp v28, v28 quad_perm:[0,0,0,0] row_mask:0xf bank_mask:0xf
    v_add_f32_dpp v28, v29, v28 quad_perm:[1,1,1,1] row_mask:0xf bank_mask:0xf
    v_add_f32_dpp v28, v30, v28 quad_perm:[2,2,2,2] row_mask:0xf bank_mask:0xf
    v_add_f32_dpp v41, v31, v28 quad_perm:[3,3,3,3] row_mask:0xf bank_mask:0x5
    s_nop 1
    v_mov_b32_dpp v20, v20 quad_perm:[0,0,0,0] row_mask:0xf bank_mask:0xf
    v_add_f32_dpp v20, v21, v20 quad_perm:[1,1,1,1] row_mask:0xf bank_mask:0xf
    v_add_f32_dpp v20, v22, v20 quad_perm:[2,2,2,2] row_mask:0xf bank_mask:0xf
    v_add_f32 v20, s33, v20
    v_add_f32_dpp v41, v23, v20 quad_perm:[3,3,3,3] row_mask:0xf bank_mask:0xa
    v_max_f32 v34, v34, v41
    s_nop 1
    v_max_f32_dpp v34, v34, v34 row_half_mirror row_mask:0xf bank_mask:0xf
    v_mov_b32 v7, v34
    s_nop 1
    v_permlane32_swap_b32 v34, v7
    v_max_f32 v34, v34, v7
    v_mov_b32 v7, v34
    s_nop 1
    v_permlane16_swap_b32 v34, v7
    v_max_f32 v34, v34, v7
    v_mul_f32 v32, s36, v34
    v_mov_b32 v33, 0
    ds_write_b32 v4, v32
    v_fma_f32 v37, v37, s36, -v32
    v_exp_f32 v37, v37
    v_fma_f32 v38, v38, s36, -v32
    v_exp_f32 v38, v38
    v_add_f32 v33, v33, v37
    v_cvt_pk_bf16_f32 v28, v37, v37
    v_and_b32 v20, v28, v8
    v_and_b32 v21, v28, v9
    v_and_b32_dpp v22, v28, v10 row_shr:4 row_mask:0xf bank_mask:0xf bound_ctrl:0
    v_and_b32_dpp v23, v28, v11 row_shr:4 row_mask:0xf bank_mask:0xf bound_ctrl:0
    v_and_b32 v26, v28, v10
    v_and_b32 v27, v28, v11
    v_mfma_f32_16x16x32_bf16 v[12:15], v[20:23], v[152:155], 0
    v_and_b32_dpp v24, v28, v8 row_shl:4 row_mask:0xf bank_mask:0xf bound_ctrl:0
    v_and_b32_dpp v25, v28, v9 row_shl:4 row_mask:0xf bank_mask:0xf bound_ctrl:0
    v_mfma_f32_16x16x32_bf16 v[16:19], v[20:23], v[156:159], 0
    v_add_f32 v33, v33, v38
    v_cvt_pk_bf16_f32 v29, v38, v38
    v_fma_f32 v39, v39, s36, -v32
    v_exp_f32 v39, v39
    v_mfma_f32_16x16x32_bf16 v[12:15], v[24:27], v[160:163], v[12:15]
    v_and_b32 v20, v29, v8
    v_and_b32 v21, v29, v9
    v_and_b32_dpp v22, v29, v10 row_shr:4 row_mask:0xf bank_mask:0xf bound_ctrl:0
    v_and_b32_dpp v23, v29, v11 row_shr:4 row_mask:0xf bank_mask:0xf bound_ctrl:0
    v_mfma_f32_16x16x32_bf16 v[16:19], v[24:27], v[164:167], v[16:19]
    v_and_b32 v26, v29, v10
    v_and_b32 v27, v29, v11
    v_mfma_f32_16x16x32_bf16 v[12:15], v[20:23], v[168:171], v[12:15]
    v_and_b32_dpp v24, v29, v8 row_shl:4 row_mask:0xf bank_mask:0xf bound_ctrl:0
    v_and_b32_dpp v25, v29, v9 row_shl:4 row_mask:0xf bank_mask:0xf bound_ctrl:0
    v_mfma_f32_16x16x32_bf16 v[16:19], v[20:23], v[172:175], v[16:19]
    v_add_f32 v33, v33, v39
    v_cvt_pk_bf16_f32 v28, v39, v39
    v_fma_f32 v40, v40, s36, -v32
    v_exp_f32 v40, v40
    v_mfma_f32_16x16x32_bf16 v[12:15], v[24:27], v[176:179], v[12:15]
    v_and_b32 v20, v28, v8
    v_and_b32 v21, v28, v9
    v_and_b32_dpp v22, v28, v10 row_shr:4 row_mask:0xf bank_mask:0xf bound_ctrl:0
    v_and_b32_dpp v23, v28, v11 row_shr:4 row_mask:0xf bank_mask:0xf bound_ctrl:0
    v_mfma_f32_16x16x32_bf16 v[16:19], v[24:27], v[180:183], v[16:19]
    v_and_b32 v26, v28, v10
    v_and_b32 v27, v28, v11
    v_mfma_f32_16x16x32_bf16 v[12:15], v[20:23], v[184:187], v[12:15]
    v_and_b32_dpp v24, v28, v8 row_shl:4 row_mask:0xf bank_mask:0xf bound_ctrl:0
    v_and_b32_dpp v25, v28, v9 row_shl:4 row_mask:0xf bank_mask:0xf bound_ctrl:0
    v_mfma_f32_16x16x32_bf16 v[16:19], v[20:23], v[188:191], v[16:19]
    v_add_u32 v7, s58, v3
    s_waitcnt lgkmcnt(0)
    s_barrier
    ds_read_b64 v[30:31], v3
    ds_read_b64 v[42:43], v3 offset:8
    ds_read_b32 v7, v7
    v_add_f32 v33, v33, v40
    v_cvt_pk_bf16_f32 v29, v40, v40
    v_fma_f32 v41, v41, s36, -v32
    v_exp_f32 v41, v41
    v_mfma_f32_16x16x32_bf16 v[12:15], v[24:27], v[192:195], v[12:15]
    v_and_b32 v20, v29, v8
    v_and_b32 v21, v29, v9
    v_and_b32_dpp v22, v29, v10 row_shr:4 row_mask:0xf bank_mask:0xf bound_ctrl:0
    v_and_b32_dpp v23, v29, v11 row_shr:4 row_mask:0xf bank_mask:0xf bound_ctrl:0
    v_mfma_f32_16x16x32_bf16 v[16:19], v[24:27], v[196:199], v[16:19]
    v_and_b32 v26, v29, v10
    v_and_b32 v27, v29, v11
    v_mfma_f32_16x16x32_bf16 v[12:15], v[20:23], v[200:203], v[12:15]
    v_and_b32_dpp v24, v29, v8 row_shl:4 row_mask:0xf bank_mask:0xf bound_ctrl:0
    v_and_b32_dpp v25, v29, v9 row_shl:4 row_mask:0xf bank_mask:0xf bound_ctrl:0
    v_mfma_f32_16x16x32_bf16 v[16:19], v[20:23], v[204:207], v[16:19]
    v_add_f32 v33, v33, v41
    v_cvt_pk_bf16_f32 v28, v41, v41
    v_and_b32 v20, v28, v8
    v_and_b32 v21, v28, v9
    v_and_b32_dpp v22, v28, v10 row_shr:4 row_mask:0xf bank_mask:0xf bound_ctrl:0
    v_mfma_f32_16x16x32_bf16 v[12:15], v[24:27], v[208:211], v[12:15]
    v_and_b32_dpp v23, v28, v11 row_shr:4 row_mask:0xf bank_mask:0xf bound_ctrl:0
    s_waitcnt lgkmcnt(0)
    v_max3_f32 v34, v30, v31, v42
    v_max_f32 v34, v34, v43
    v_sub_f32 v30, v7, v34
    v_exp_f32 v30, v30
    v_mfma_f32_16x16x32_bf16 v[16:19], v[24:27], v[212:215], v[16:19]
    v_and_b32 v26, v28, v10
    v_and_b32 v27, v28, v11
    v_mfma_f32_16x16x32_bf16 v[12:15], v[20:23], v[216:219], v[12:15]
    v_and_b32_dpp v24, v28, v8 row_shl:4 row_mask:0xf bank_mask:0xf bound_ctrl:0
    v_and_b32_dpp v25, v28, v9 row_shl:4 row_mask:0xf bank_mask:0xf bound_ctrl:0
    v_mfma_f32_16x16x32_bf16 v[16:19], v[20:23], v[220:223], v[16:19]
    s_nop 0
    v_mfma_f32_16x16x32_bf16 v[12:15], v[24:27], v[224:227], v[12:15]
    v_mfma_f32_16x16x32_bf16 v[16:19], v[24:27], v[228:231], v[16:19]
    s_branch L_reduce
L_att_end:
    s_branch L_fin
L_chain:
    s_waitcnt lgkmcnt(0)
    s_mov_b32 s36, 1035512379
    s_mov_b32 s43, 262144
    s_mov_b32 s42, 0
    s_getreg_b32 s34, hwreg(HW_REG_XCC_ID, 0, 4)
    s_min_u32 s34, s34, 14
    s_add_u32 s34, s34, 1
    s_mul_i32 s34, s34, 0x01010101
    s_mov_b32 s35, 0
    s_mov_b32 s20, s76
    s_and_b32 s21, s77, 0xffff
    s_mov_b32 s22, 283117312
    s_mov_b32 s23, 0x20000
    s_mov_b32 s24, s74
    s_and_b32 s25, s75, 0xffff
    s_mov_b32 s26, 256
    s_mov_b32 s27, 0x20000
    s_mov_b32 s4, s58
    s_and_b32 s5, s59, 0xffff
    s_mov_b32 s6, 3670016
    s_mov_b32 s7, 0x20000
    s_mov_b32 s8, s60
    s_and_b32 s9, s61, 0xffff
    s_mov_b32 s10, 3670016
    s_mov_b32 s11, 0x20000
    s_mov_b32 s12, s68
    s_and_b32 s13, s69, 0xffff
    s_mov_b32 s14, 3670016
    s_mov_b32 s15, 0x20000
    s_mov_b32 s16, s70
    s_and_b32 s17, s71, 0xffff
    s_mov_b32 s18, 3670016
    s_mov_b32 s19, 0x20000
    s_mov_b32 s28, s52
    s_and_b32 s29, s53, 0xffff
    s_mov_b32 s30, 896
    s_mov_b32 s31, 0x20000
    s_mov_b64 s[32:33], s[72:73]
    s_mov_b64 s[0:1], s[64:65]
    s_lshl_b32 s38, s48, 2
    s_add_u32 s49, s38, s49
    v_lshrrev_b32 v20, 4, v0
    v_and_b32 v21, 15, v0
    v_lshlrev_b32 v22, 4, v21
    s_lshr_b32 s38, s3, 1
    s_lshl_b32 s38, s38, 2
    v_or_b32 v23, s38, v20
    v_lshlrev_b32 v23, 5, v23
    v_xor_b32 v23, v23, v22
    v_lshl_add_u32 v1, v20, 13, v23
    v_mul_u32_u24 v2, 896, v20
    v_add_u32 v2, v2, v22
    v_and_b32 v23, 31, v0
    v_min_u32 v23, 27, v23
    v_lshrrev_b32 v24, 5, v0
    s_mul_i32 s38, s3, 224
    v_lshlrev_b32 v25, 3, v23
    v_lshl_add_u32 v25, v24, 2, v25
    v_add_u32 v25, s38, v25
    buffer_load_dword v12, v25, s[28:31], 0 offen
    v_add_u32 v17, 135168, v25
    v_lshlrev_b32 v6, 4, v23
    v_lshl_add_u32 v6, v24, 11, v6
    v_lshlrev_b32 v5, 4, v0
    s_lshl_b32 s50, s49, 10
    s_add_u32 s50, s50, 49152
    s_lshl_b32 s51, s49, 8
    v_mov_b32 v28, -1
    v_mov_b32 v29, -1
    v_mov_b32 v30, -1
    v_mov_b32 v31, -1
    s_lshl_b32 s39, s3, 13
    s_add_u32 s39, s39, s51
    s_cmp_eq_u32 s3, 0
    s_cbranch_scc0 L_ch_cl1
    buffer_store_dwordx4 v[28:31], v5, s[20:23], s50 offen sc1
L_ch_cl1:
    s_mov_b64 exec, 0xffff
    buffer_store_dwordx4 v[28:31], v5, s[20:23], s39 offen sc1
    s_mov_b64 exec, -1
    s_lshl_b32 s38, s3, 15
    s_lshl_b32 s39, s49, 8
    s_add_u32 s38, s38, s39
    s_lshl_b32 s40, s3, 10
    s_add_u32 s39, s38, 0
    s_add_u32 s41, s40, 0
    s_mov_b32 m0, s41
    s_nop 0
    buffer_load_dwordx4 v1, s[4:7], s39 offen nt lds
    s_add_u32 s39, s38, 131072
    s_add_u32 s41, s40, 4096
    s_mov_b32 m0, s41
    s_nop 0
    buffer_load_dwordx4 v1, s[4:7], s39 offen nt lds
    s_add_u32 s39, s38, 262144
    s_add_u32 s41, s40, 8192
    s_mov_b32 m0, s41
    s_nop 0
    buffer_load_dwordx4 v1, s[4:7], s39 offen nt lds
    s_add_u32 s39, s38, 393216
    s_add_u32 s41, s40, 12288
    s_mov_b32 m0, s41
    s_nop 0
    buffer_load_dwordx4 v1, s[4:7], s39 offen nt lds
    s_add_u32 s39, s38, 524288
    s_add_u32 s41, s40, 16384
    s_mov_b32 m0, s41
    s_nop 0
    buffer_load_dwordx4 v1, s[4:7], s39 offen nt lds
    s_add_u32 s39, s38, 655360
    s_add_u32 s41, s40, 20480
    s_mov_b32 m0, s41
    s_nop 0
    buffer_load_dwordx4 v1, s[4:7], s39 offen nt lds
    s_add_u32 s39, s38, 786432
    s_add_u32 s41, s40, 24576
    s_mov_b32 m0, s41
    s_nop 0
    buffer_load_dwordx4 v1, s[4:7], s39 offen nt lds
    s_add_u32 s39, s38, 917504
    s_add_u32 s41, s40, 28672
    s_mov_b32 m0, s41
    s_nop 0
    buffer_load_dwordx4 v1, s[4:7], s39 offen nt lds
    s_add_u32 s39, s38, 1048576
    s_add_u32 s41, s40, 32768
    s_mov_b32 m0, s41
    s_nop 0
    buffer_load_dwordx4 v1, s[4:7], s39 offen nt lds
    s_add_u32 s39, s38, 1179648
    s_add_u32 s41, s40, 36864
    s_mov_b32 m0, s41
    s_nop 0
    buffer_load_dwordx4 v1, s[4:7], s39 offen nt lds
    s_add_u32 s39, s38, 1310720
    s_add_u32 s41, s40, 40960
    s_mov_b32 m0, s41
    s_nop 0
    buffer_load_dwordx4 v1, s[4:7], s39 offen nt lds
    s_add_u32 s39, s38, 1441792
    s_add_u32 s41, s40, 45056
    s_mov_b32 m0, s41
    s_nop 0
    buffer_load_dwordx4 v1, s[4:7], s39 offen nt lds
    s_add_u32 s39, s38, 1572864
    s_add_u32 s41, s40, 49152
    s_mov_b32 m0, s41
    s_nop 0
    buffer_load_dwordx4 v1, s[4:7], s39 offen nt lds
    s_add_u32 s39, s38, 1703936
    s_add_u32 s41, s40, 53248
    s_mov_b32 m0, s41
    s_nop 0
    buffer_load_dwordx4 v1, s[4:7], s39 offen nt lds
    s_add_u32 s39, s38, 1835008
    s_add_u32 s41, s40, 57344
    s_mov_b32 m0, s41
    s_nop 0
    buffer_load_dwordx4 v1, s[4:7], s39 offen nt lds
    s_add_u32 s39, s38, 1966080
    s_add_u32 s41, s40, 61440
    s_mov_b32 m0, s41
    s_nop 0
    buffer_load_dwordx4 v1, s[4:7], s39 offen nt lds
    s_add_u32 s39, s38, 2097152
    s_add_u32 s41, s40, 65536
    s_mov_b32 m0, s41
    s_nop 0
    buffer_load_dwordx4 v1, s[4:7], s39 offen nt lds
    s_add_u32 s39, s38, 2228224
    s_add_u32 s41, s40, 69632
    s_mov_b32 m0, s41
    s_nop 0
    buffer_load_dwordx4 v1, s[4:7], s39 offen nt lds
    s_add_u32 s39, s38, 2359296
    s_add_u32 s41, s40, 73728
    s_mov_b32 m0, s41
    s_nop 0
    buffer_load_dwordx4 v1, s[4:7], s39 offen nt lds
    s_add_u32 s39, s38, 2490368
    s_add_u32 s41, s40, 77824
    s_mov_b32 m0, s41
    s_nop 0
    buffer_load_dwordx4 v1, s[4:7], s39 offen nt lds
    s_add_u32 s39, s38, 2621440
    s_add_u32 s41, s40, 81920
    s_mov_b32 m0, s41
    s_nop 0
    buffer_load_dwordx4 v1, s[4:7], s39 offen nt lds
    s_add_u32 s39, s38, 2752512
    s_add_u32 s41, s40, 86016
    s_mov_b32 m0, s41
    s_nop 0
    buffer_load_dwordx4 v1, s[4:7], s39 offen nt lds
    s_add_u32 s39, s38, 2883584
    s_add_u32 s41, s40, 90112
    s_mov_b32 m0, s41
    s_nop 0
    buffer_load_dwordx4 v1, s[4:7], s39 offen nt lds
    s_add_u32 s39, s38, 3014656
    s_add_u32 s41, s40, 94208
    s_mov_b32 m0, s41
    s_nop 0
    buffer_load_dwordx4 v1, s[4:7], s39 offen nt lds
    s_add_u32 s39, s38, 3145728
    s_add_u32 s41, s40, 98304
    s_mov_b32 m0, s41
    s_nop 0
    buffer_load_dwordx4 v1, s[4:7], s39 offen nt lds
    s_add_u32 s39, s38, 3276800
    s_add_u32 s41, s40, 102400
    s_mov_b32 m0, s41
    s_nop 0
    buffer_load_dwordx4 v1, s[4:7], s39 offen nt lds
    s_add_u32 s39, s38, 3407872
    s_add_u32 s41, s40, 106496
    s_mov_b32 m0, s41
    s_nop 0
    buffer_load_dwordx4 v1, s[4:7], s39 offen nt lds
    s_add_u32 s39, s38, 3538944
    s_add_u32 s41, s40, 110592
    s_mov_b32 m0, s41
    s_nop 0
    buffer_load_dwordx4 v1, s[4:7], s39 offen nt lds
    v_mul_u32_u24 v3, 7168, v20
    v_add_u32 v3, v3, v22
    s_lshl_b32 s38, s3, 8
    v_add_u32 v3, s38, v3
    v_min_u32 v23, 6, v21
    v_mul_u32_u24 v24, 7, v20
    v_add_u32 v23, v23, v24
    v_lshlrev_b32 v4, 7, v23
    v_cmp_gt_u32 vcc, 7, v21
    s_nop 1
    v_cndmask_b32 v14, 0, 1.0, vcc
    v_cmp_gt_u32 vcc, 56, v0
    s_nop 1
    v_cndmask_b32 v95, 0, 1.0, vcc
    v_lshrrev_b32 v23, 5, v0
    v_lshlrev_b32 v23, 9, v23
    v_lshl_add_u32 v23, v21, 5, v23
    v_and_b32 v24, 1, v20
    v_lshl_add_u32 v15, v24, 4, v23
    s_lshl_b32 s38, s3, 6
    v_lshl_add_u32 v94, v0, 1, s38
    v_add_u32 v16, 131072, v5
    v_lshlrev_b32 v18, 4, v20
    v_add_u32 v18, 135168, v18
    v_min_u32 v19, 55, v0
    v_lshlrev_b32 v19, 4, v19
    v_add_u32 v19, 135168, v19
    s_lshr_b32 s38, s49, 1
    s_mul_i32 s45, s38, 28672
    s_add_u32 s45, s45, 196608
    s_lshl_b32 s46, s38, 12
    s_add_u32 s46, s46, 2031616
    s_mul_i32 s47, s3, 448
    s_add_u32 s47, s47, 49152
    v_and_b32 v20, 1, v0
    v_lshlrev_b32 v20, 4, v20
    v_mov_b32 v21, 0xffff
    v_lshlrev_b32 v20, v20, v21
    v_bfe_u32 v21, v0, 1, 2
    v_cmp_eq_u32 vcc, 0, v21
    s_nop 1
    v_cndmask_b32 v8, 0, v20, vcc
    v_cmp_eq_u32 vcc, 1, v21
    s_nop 1
    v_cndmask_b32 v9, 0, v20, vcc
    v_cmp_eq_u32 vcc, 2, v21
    s_nop 1
    v_cndmask_b32 v10, 0, v20, vcc
    v_cmp_eq_u32 vcc, 3, v21
    s_nop 1
    v_cndmask_b32 v11, 0, v20, vcc
    s_waitcnt vmcnt(0)
    s_lshr_b32 s38, s49, 1
    s_lshl_b32 s38, s38, 2
    s_add_u32 s38, s38, s3
    s_mul_i32 s38, s38, 57344
    s_and_b32 s39, s49, 1
    s_lshl_b32 s39, s39, 9
    s_add_u32 s38, s38, s39
    s_add_u32 s39, s38, 0
    buffer_load_dwordx4 v[96:99], v2, s[8:11], s39 offen nt
    s_add_u32 s39, s38, 3584
    buffer_load_dwordx4 v[100:103], v2, s[8:11], s39 offen nt
    s_add_u32 s39, s38, 7168
    buffer_load_dwordx4 v[104:107], v2, s[8:11], s39 offen nt
    s_add_u32 s39, s38, 10752
    buffer_load_dwordx4 v[108:111], v2, s[8:11], s39 offen nt
    s_add_u32 s39, s38, 14336
    buffer_load_dwordx4 v[112:115], v2, s[8:11], s39 offen nt
    s_add_u32 s39, s38, 17920
    buffer_load_dwordx4 v[116:119], v2, s[8:11], s39 offen nt
    s_add_u32 s39, s38, 21504
    buffer_load_dwordx4 v[120:123], v2, s[8:11], s39 offen nt
    s_add_u32 s39, s38, 25088
    buffer_load_dwordx4 v[124:127], v2, s[8:11], s39 offen nt
    s_mov_b32 s28, s32
    s_and_b32 s29, s33, 0xffff
    s_mov_b32 s30, 896
    s_mov_b32 s31, 0x20000
    ds_write_b32 v17, v12
    v_and_b32 v13, 0xffff0000, v12
    v_lshlrev_b32 v12, 16, v12
    s_waitcnt lgkmcnt(0)
    s_barrier
    s_cmp_eq_u32 s3, 3
    s_cbranch_scc0 L_ch_noflag
    s_lshl_b32 s38, s48, 5
    s_and_b32 s39, s49, 3
    s_add_u32 s38, s38, s39
    v_mov_b32 v28, s38
    v_mov_b32 v29, s34
    s_mov_b64 exec, 1
    buffer_store_byte v29, v28, s[24:27], 0 offen sc1
    s_mov_b64 exec, -1
L_ch_noflag:
    v_lshrrev_b32 v20, 4, v0
    v_bfe_u32 v21, v0, 2, 2
    v_and_b32 v22, 1, v20
    v_lshl_add_u32 v22, v22, 2, v21
    s_lshl_b32 s38, s3, 1
    v_xor_b32 v22, s38, v22
    v_lshlrev_b32 v22, 5, v22
    v_lshl_add_u32 v20, v20, 3, v21
    v_lshl_add_u32 v20, v20, 8, v22
    v_and_b32 v21, 3, v0
    v_lshl_add_u32 v20, v21, 3, v20
    v_xor_b32 v21, 32, v20
    v_add_u32 v22, 57344, v20
    v_add_u32 v23, 57344, v21
    ds_read_b64_tr_b16 a[0:1], v20 offset:0
    ds_read_b64_tr_b16 a[2:3], v20 offset:1024
    ds_read_b64_tr_b16 a[4:5], v21 offset:0
    ds_read_b64_tr_b16 a[6:7], v21 offset:1024
    ds_read_b64_tr_b16 a[8:9], v20 offset:8192
    ds_read_b64_tr_b16 a[10:11], v20 offset:9216
    ds_read_b64_tr_b16 a[12:13], v21 offset:8192
    ds_read_b64_tr_b16 a[14:15], v21 offset:9216
    ds_read_b64_tr_b16 a[16:17], v20 offset:16384
    ds_read_b64_tr_b16 a[18:19], v20 offset:17408
    ds_read_b64_tr_b16 a[20:21], v21 offset:16384
    ds_read_b64_tr_b16 a[22:23], v21 offset:17408
    s_waitcnt lgkmcnt(3)
    ds_read_b64_tr_b16 a[24:25], v20 offset:24576
    ds_read_b64_tr_b16 a[26:27], v20 offset:25600
    ds_read_b64_tr_b16 a[28:29], v21 offset:24576
    ds_read_b64_tr_b16 a[30:31], v21 offset:25600
    ds_read_b64_tr_b16 a[32:33], v20 offset:32768
    ds_read_b64_tr_b16 a[34:35], v20 offset:33792
    ds_read_b64_tr_b16 a[36:37], v21 offset:32768
    ds_read_b64_tr_b16 a[38:39], v21 offset:33792
    ds_read_b64_tr_b16 a[40:41], v20 offset:40960
    ds_read_b64_tr_b16 a[42:43], v20 offset:41984
    ds_read_b64_tr_b16 a[44:45], v21 offset:40960
    ds_read_b64_tr_b16 a[46:47], v21 offset:41984
    s_waitcnt lgkmcnt(3)
    ds_read_b64_tr_b16 a[48:49], v20 offset:49152
    ds_read_b64_tr_b16 a[50:51], v20 offset:50176
    ds_read_b64_tr_b16 a[52:53], v21 offset:49152
    ds_read_b64_tr_b16 a[54:55], v21 offset:50176
    ds_read_b64_tr_b16 a[56:57], v22 offset:0
    ds_read_b64_tr_b16 a[58:59], v22 offset:1024
    ds_read_b64_tr_b16 a[60:61], v23 offset:0
    ds_read_b64_tr_b16 a[62:63], v23 offset:1024
    ds_read_b64_tr_b16 a[64:65], v22 offset:8192
    ds_read_b64_tr_b16 a[66:67], v22 offset:9216
    ds_read_b64_tr_b16 a[68:69], v23 offset:8192
    ds_read_b64_tr_b16 a[70:71], v23 offset:9216
    s_waitcnt lgkmcnt(3)
    ds_read_b64_tr_b16 a[72:73], v22 offset:16384
    ds_read_b64_tr_b16 a[74:75], v22 offset:17408
    ds_read_b64_tr_b16 a[76:77], v23 offset:16384
    ds_read_b64_tr_b16 a[78:79], v23 offset:17408
    ds_read_b64_tr_b16 a[80:81], v22 offset:24576
    ds_read_b64_tr_b16 a[82:83], v22 offset:25600
    ds_read_b64_tr_b16 a[84:85], v23 offset:24576
    ds_read_b64_tr_b16 a[86:87], v23 offset:25600
    ds_read_b64_tr_b16 a[88:89], v22 offset:32768
    ds_read_b64_tr_b16 a[90:91], v22 offset:33792
    ds_read_b64_tr_b16 a[92:93], v23 offset:32768
    ds_read_b64_tr_b16 a[94:95], v23 offset:33792
    s_waitcnt lgkmcnt(3)
    ds_read_b64_tr_b16 a[96:97], v22 offset:40960
    ds_read_b64_tr_b16 a[98:99], v22 offset:41984
    ds_read_b64_tr_b16 a[100:101], v23 offset:40960
    ds_read_b64_tr_b16 a[102:103], v23 offset:41984
    ds_read_b64_tr_b16 a[104:105], v22 offset:49152
    ds_read_b64_tr_b16 a[106:107], v22 offset:50176
    ds_read_b64_tr_b16 a[108:109], v23 offset:49152
    ds_read_b64_tr_b16 a[110:111], v23 offset:50176
    s_waitcnt lgkmcnt(0)
    v_mov_b32 v20, 0x3f803f80
    v_mov_b32 v21, 0x3f803f80
    v_mov_b32 v22, 0x3f803f80
    v_mov_b32 v23, 0x3f803f80
    s_nop 1
    v_mfma_f32_16x16x32_bf16 v[28:31], v[20:23], a[0:3], 0
    v_mfma_f32_16x16x32_bf16 v[32:35], v[20:23], a[4:7], 0
    v_mfma_f32_16x16x32_bf16 v[28:31], v[20:23], a[8:11], v[28:31]
    v_mfma_f32_16x16x32_bf16 v[32:35], v[20:23], a[12:15], v[32:35]
    v_mfma_f32_16x16x32_bf16 v[28:31], v[20:23], a[16:19], v[28:31]
    v_mfma_f32_16x16x32_bf16 v[32:35], v[20:23], a[20:23], v[32:35]
    v_mfma_f32_16x16x32_bf16 v[28:31], v[20:23], a[24:27], v[28:31]
    v_mfma_f32_16x16x32_bf16 v[32:35], v[20:23], a[28:31], v[32:35]
    v_mfma_f32_16x16x32_bf16 v[28:31], v[20:23], a[32:35], v[28:31]
    v_mfma_f32_16x16x32_bf16 v[32:35], v[20:23], a[36:39], v[32:35]
    v_mfma_f32_16x16x32_bf16 v[28:31], v[20:23], a[40:43], v[28:31]
    v_mfma_f32_16x16x32_bf16 v[32:35], v[20:23], a[44:47], v[32:35]
    v_mfma_f32_16x16x32_bf16 v[28:31], v[20:23], a[48:51], v[28:31]
    v_mfma_f32_16x16x32_bf16 v[32:35], v[20:23], a[52:55], v[32:35]
    v_mfma_f32_16x16x32_bf16 v[28:31], v[20:23], a[56:59], v[28:31]
    v_mfma_f32_16x16x32_bf16 v[32:35], v[20:23], a[60:63], v[32:35]
    v_mfma_f32_16x16x32_bf16 v[28:31], v[20:23], a[64:67], v[28:31]
    v_mfma_f32_16x16x32_bf16 v[32:35], v[20:23], a[68:71], v[32:35]
    v_mfma_f32_16x16x32_bf16 v[28:31], v[20:23], a[72:75], v[28:31]
    v_mfma_f32_16x16x32_bf16 v[32:35], v[20:23], a[76:79], v[32:35]
    v_mfma_f32_16x16x32_bf16 v[28:31], v[20:23], a[80:83], v[28:31]
    v_mfma_f32_16x16x32_bf16 v[32:35], v[20:23], a[84:87], v[32:35]
    v_mfma_f32_16x16x32_bf16 v[28:31], v[20:23], a[88:91], v[28:31]
    v_mfma_f32_16x16x32_bf16 v[32:35], v[20:23], a[92:95], v[32:35]
    v_mfma_f32_16x16x32_bf16 v[28:31], v[20:23], a[96:99], v[28:31]
    v_mfma_f32_16x16x32_bf16 v[32:35], v[20:23], a[100:103], v[32:35]
    v_mfma_f32_16x16x32_bf16 v[28:31], v[20:23], a[104:107], v[28:31]
    v_mfma_f32_16x16x32_bf16 v[32:35], v[20:23], a[108:111], v[32:35]
    s_nop 7
    v_mov_b32 v92, v28
    s_mov_b32 exec_lo, 0xffff0000
    s_mov_b32 exec_hi, 0xffff0000
    v_mov_b32 v92, v32
    s_mov_b64 exec, -1
    v_and_b32 v7, 7, v0
    v_lshlrev_b32 v7, 2, v7
    s_lshl_b32 s40, s48, 5
L_ch_id:
    s_cmp_eq_u32 s43, 0
    s_cbranch_scc1 L_ch_id_ok
    s_sub_u32 s43, s43, 1
    buffer_load_dword v36, v7, s[24:27], s40 offen sc1
    s_waitcnt vmcnt(0)
    v_and_b32 v37, 0x0f0f0f0f, v36
    v_cmp_ne_u32 s[38:39], s34, v37
    v_add_u32 v37, 0x7f7f7f7f, v36
    v_and_b32 v37, 0x80808080, v37
    v_cmp_ne_u32 vcc, 0x80808080, v37
    s_cmp_eq_u64 s[38:39], 0
    s_cselect_b32 s35, 1, 0
    s_cmp_lg_u64 vcc, 0
    s_cbranch_scc1 L_ch_id
L_ch_id_ok:
    v_mov_b32 v28, -1
    v_mov_b32 v29, -1
    v_mov_b32 v30, -1
    v_mov_b32 v31, -1
    s_mul_i32 s39, s3, 7168
    s_add_u32 s39, s39, s45
    s_add_u32 s40, s39, 4096
    s_mul_i32 s38, s3, 896
    s_add_u32 s38, s38, s46
    v_lshlrev_b32 v7, 7, v0
    s_cmp_eq_u32 s35, 1
    s_cbranch_scc0 L_ch_clf
    buffer_store_dwordx4 v[28:31], v5, s[20:23], s39 offen offset:0
    buffer_store_dwordx4 v[28:31], v5, s[20:23], s39 offen offset:1024
    buffer_store_dwordx4 v[28:31], v5, s[20:23], s39 offen offset:2048
    buffer_store_dwordx4 v[28:31], v5, s[20:23], s39 offen offset:3072
    buffer_store_dwordx4 v[28:31], v5, s[20:23], s40 offen offset:0
    buffer_store_dwordx4 v[28:31], v5, s[20:23], s40 offen offset:1024
    buffer_store_dwordx4 v[28:31], v5, s[20:23], s40 offen offset:2048
    s_mov_b64 exec, 0x7f
    buffer_store_dwordx2 v[28:29], v7, s[20:23], s38 offen
    s_mov_b64 exec, -1
    s_branch L_ch_cld
L_ch_clf:
    buffer_store_dwordx4 v[28:31], v5, s[20:23], s39 offen offset:0 sc1
    buffer_store_dwordx4 v[28:31], v5, s[20:23], s39 offen offset:1024 sc1
    buffer_store_dwordx4 v[28:31], v5, s[20:23], s39 offen offset:2048 sc1
    buffer_store_dwordx4 v[28:31], v5, s[20:23], s39 offen offset:3072 sc1
    buffer_store_dwordx4 v[28:31], v5, s[20:23], s40 offen offset:0 sc1
    buffer_store_dwordx4 v[28:31], v5, s[20:23], s40 offen offset:1024 sc1
    buffer_store_dwordx4 v[28:31], v5, s[20:23], s40 offen offset:2048 sc1
    s_mov_b64 exec, 0x7f
    buffer_store_dwordx2 v[28:29], v7, s[20:23], s38 offen sc1
    s_mov_b64 exec, -1
L_ch_cld:
    s_waitcnt vmcnt(0)
    s_barrier
    s_lshr_b32 s38, s49, 1
    s_lshl_b32 s38, s38, 2
    s_add_u32 s38, s38, s3
    s_mul_i32 s38, s38, 57344
    s_and_b32 s39, s49, 1
    s_lshl_b32 s39, s39, 9
    s_add_u32 s38, s38, s39
    s_add_u32 s39, s38, 28672
    buffer_load_dwordx4 v[128:131], v2, s[8:11], s39 offen nt
    s_add_u32 s39, s38, 32256
    buffer_load_dwordx4 v[132:135], v2, s[8:11], s39 offen nt
    s_add_u32 s39, s38, 35840
    buffer_load_dwordx4 v[136:139], v2, s[8:11], s39 offen nt
    s_add_u32 s39, s38, 39424
    buffer_load_dwordx4 v[140:143], v2, s[8:11], s39 offen nt
    s_add_u32 s39, s38, 43008
    buffer_load_dwordx4 v[144:147], v2, s[8:11], s39 offen nt
    s_add_u32 s39, s38, 46592
    buffer_load_dwordx4 v[148:151], v2, s[8:11], s39 offen nt
    s_add_u32 s39, s38, 50176
    buffer_load_dwordx4 v[152:155], v2, s[8:11], s39 offen nt
    s_add_u32 s39, s38, 53760
    buffer_load_dwordx4 v[156:159], v2, s[8:11], s39 offen nt
    s_branch L_ch_qp
L_ch_stageA:
    s_and_b32 s38, s42, 1
    s_lshl_b32 s38, s38, 16
    s_lshl_b32 s39, s3, 14
    s_add_u32 s38, s38, s39
    v_add_u32 v7, s38, v5
    ds_read_b128 v[224:227], v7 offset:0
    ds_read_b128 v[228:231], v7 offset:1024
    ds_read_b128 v[232:235], v7 offset:2048
    ds_read_b128 v[236:239], v7 offset:3072
    ds_read_b128 v[240:243], v7 offset:4096
    ds_read_b128 v[244:247], v7 offset:5120
    ds_read_b128 v[248:251], v7 offset:6144
    ds_read_b128 v[252:255], v7 offset:7168
    s_waitcnt lgkmcnt(0)
    ds_read_b128 a[224:227], v7 offset:8192
    ds_read_b128 a[228:231], v7 offset:9216
    ds_read_b128 a[232:235], v7 offset:10240
    ds_read_b128 a[236:239], v7 offset:11264
    ds_read_b128 a[240:243], v7 offset:12288
    ds_read_b128 a[244:247], v7 offset:13312
    ds_read_b128 a[248:251], v7 offset:14336
    ds_read_b128 a[252:255], v7 offset:15360
    s_add_u32 s52, s47, 0
    s_add_u32 s53, s47, 4096
    s_add_u32 s54, s47, 8192
    s_add_u32 s55, s47, 12288
    s_add_u32 s56, s47, 16384
    s_add_u32 s57, s47, 20480
    s_add_u32 s58, s47, 24576
    s_add_u32 s59, s47, 28672
    s_waitcnt lgkmcnt(0)
    s_cmp_eq_u32 s3, 0
    s_cbranch_scc0 L_sa_nc
    s_cmp_eq_u32 s42, 3
    s_cbranch_scc1 L_sa_nc
    v_mov_b32 v28, -1
    v_mov_b32 v29, -1
    v_mov_b32 v30, -1
    v_mov_b32 v31, -1
    s_add_u32 s38, s50, 32768
    buffer_store_dwordx4 v[28:31], v5, s[20:23], s38 offen sc1
L_sa_nc:
    s_add_u32 s38, s45, 4096
    s_branch L_sa_poll
L_sa_again:
    s_cmp_eq_u32 s43, 0
    s_cbranch_scc1 L_sa_on
    s_sub_u32 s43, s43, 1
    s_waitcnt vmcnt(0)
L_sa_poll:
    buffer_load_dwordx2 v[64:65], v4, s[20:23], s46 offen sc1
    buffer_load_dwordx4 v[36:39], v3, s[20:23], s45 offen offset:0 sc1
    buffer_load_dwordx4 v[40:43], v3, s[20:23], s45 offen offset:1024 sc1
    buffer_load_dwordx4 v[44:47], v3, s[20:23], s45 offen offset:2048 sc1
    buffer_load_dwordx4 v[48:51], v3, s[20:23], s45 offen offset:3072 sc1
    buffer_load_dwordx4 v[52:55], v3, s[20:23], s38 offen offset:0 sc1
    buffer_load_dwordx4 v[56:59], v3, s[20:23], s38 offen offset:1024 sc1
    buffer_load_dwordx4 v[60:63], v3, s[20:23], s38 offen offset:2048 sc1
    s_waitcnt vmcnt(7)
    v_max_u32 v7, v64, v65
    v_cmp_eq_u32 vcc, -1, v7
    v_max_f32_dpp v68, v64, v64 quad_perm:[1,0,3,2] row_mask:0xf bank_mask:0xf
    s_cmp_lg_u64 vcc, 0
    s_cbranch_scc1 L_sa_again
L_sa_on:
    s_nop 1
    v_max_f32_dpp v68, v68, v68 quad_perm:[2,3,0,1] row_mask:0xf bank_mask:0xf
    s_nop 1
    v_max_f32_dpp v68, v68, v68 row_half_mirror row_mask:0xf bank_mask:0xf
    v_mov_b32 v7, v68
    s_nop 1
    v_permlane32_swap_b32 v68, v7
    v_max_f32 v68, v68, v7
    v_mov_b32 v7, v68
    s_nop 1
    v_permlane16_swap_b32 v68, v7
    v_max_f32 v68, v68, v7
    v_sub_f32 v69, v64, v68
    v_exp_f32 v69, v69
    v_mul_f32 v70, v65, v14
    v_mul_f32 v70, v70, v69
    s_waitcnt vmcnt(6)
    v_mul_f32_dpp v72, v69, v36 row_newbcast:0 row_mask:0xf bank_mask:0xf
    v_mul_f32_dpp v74, v69, v38 row_newbcast:0 row_mask:0xf bank_mask:0xf
    v_mul_f32_dpp v73, v69, v37 row_newbcast:0 row_mask:0xf bank_mask:0xf
    v_mul_f32_dpp v75, v69, v39 row_newbcast:0 row_mask:0xf bank_mask:0xf
    v_add_f32_dpp v70, v70, v70 quad_perm:[1,0,3,2] row_mask:0xf bank_mask:0xf
    s_waitcnt vmcnt(5)
    v_fmac_f32_dpp v72, v69, v40 row_newbcast:1 row_mask:0xf bank_mask:0xf
    v_fmac_f32_dpp v74, v69, v42 row_newbcast:1 row_mask:0xf bank_mask:0xf
    v_fmac_f32_dpp v73, v69, v41 row_newbcast:1 row_mask:0xf bank_mask:0xf
    v_fmac_f32_dpp v75, v69, v43 row_newbcast:1 row_mask:0xf bank_mask:0xf
    v_add_f32_dpp v70, v70, v70 quad_perm:[2,3,0,1] row_mask:0xf bank_mask:0xf
    s_waitcnt vmcnt(4)
    v_fmac_f32_dpp v72, v69, v44 row_newbcast:2 row_mask:0xf bank_mask:0xf
    v_fmac_f32_dpp v74, v69, v46 row_newbcast:2 row_mask:0xf bank_mask:0xf
    v_fmac_f32_dpp v73, v69, v45 row_newbcast:2 row_mask:0xf bank_mask:0xf
    v_fmac_f32_dpp v75, v69, v47 row_newbcast:2 row_mask:0xf bank_mask:0xf
    v_add_f32_dpp v70, v70, v70 row_half_mirror row_mask:0xf bank_mask:0xf
    s_waitcnt vmcnt(3)
    v_fmac_f32_dpp v72, v69, v48 row_newbcast:3 row_mask:0xf bank_mask:0xf
    v_fmac_f32_dpp v74, v69, v50 row_newbcast:3 row_mask:0xf bank_mask:0xf
    v_fmac_f32_dpp v73, v69, v49 row_newbcast:3 row_mask:0xf bank_mask:0xf
    v_fmac_f32_dpp v75, v69, v51 row_newbcast:3 row_mask:0xf bank_mask:0xf
    v_add_f32_dpp v70, v70, v70 row_mirror row_mask:0xf bank_mask:0xf
    v_mov_b32 v7, v70
    s_waitcnt vmcnt(2)
    v_fmac_f32_dpp v72, v69, v52 row_newbcast:4 row_mask:0xf bank_mask:0xf
    v_fmac_f32_dpp v74, v69, v54 row_newbcast:4 row_mask:0xf bank_mask:0xf
    v_fmac_f32_dpp v73, v69, v53 row_newbcast:4 row_mask:0xf bank_mask:0xf
    v_fmac_f32_dpp v75, v69, v55 row_newbcast:4 row_mask:0xf bank_mask:0xf
    v_permlane32_swap_b32 v70, v7
    v_add_f32 v70, v70, v7
    v_mov_b32 v7, v70
    s_waitcnt vmcnt(1)
    v_fmac_f32_dpp v72, v69, v56 row_newbcast:5 row_mask:0xf bank_mask:0xf
    v_fmac_f32_dpp v74, v69, v58 row_newbcast:5 row_mask:0xf bank_mask:0xf
    v_fmac_f32_dpp v73, v69, v57 row_newbcast:5 row_mask:0xf bank_mask:0xf
    v_fmac_f32_dpp v75, v69, v59 row_newbcast:5 row_mask:0xf bank_mask:0xf
    v_permlane16_swap_b32 v70, v7
    v_add_f32 v70, v70, v7
    v_rcp_f32 v70, v70
    s_waitcnt vmcnt(0)
    v_fmac_f32_dpp v72, v69, v60 row_newbcast:6 row_mask:0xf bank_mask:0xf
    v_fmac_f32_dpp v74, v69, v62 row_newbcast:6 row_mask:0xf bank_mask:0xf
    v_fmac_f32_dpp v73, v69, v61 row_newbcast:6 row_mask:0xf bank_mask:0xf
    v_fmac_f32_dpp v75, v69, v63 row_newbcast:6 row_mask:0xf bank_mask:0xf
    v_permlane32_swap_b32 v72, v74
    s_nop 0
    v_permlane32_swap_b32 v73, v75
    v_add_f32 v72, v72, v74
    v_add_f32 v73, v73, v75
    s_nop 1
    v_permlane16_swap_b32 v72, v73
    v_add_f32 v72, v72, v73
    v_mul_f32 v72, v72, v70
    v_cmp_u_f32 vcc, v72, v72
    v_cvt_pk_bf16_f32 v72, v72, v72
    s_cmp_lg_u64 vcc, 0
    s_cbranch_scc0 L_sa_go
    s_cmp_eq_u32 s43, 0
    s_cbranch_scc1 L_sa_go
    s_sub_u32 s43, s43, 1
    v_max3_u32 v7, v36, v37, v38
    v_max3_u32 v7, v7, v39, v40
    v_max3_u32 v7, v7, v41, v42
    v_max3_u32 v7, v7, v43, v44
    v_max3_u32 v7, v7, v45, v46
    v_max3_u32 v7, v7, v47, v48
    v_max3_u32 v7, v7, v49, v50
    v_max3_u32 v7, v7, v51, v52
    v_max3_u32 v7, v7, v53, v54
    v_max3_u32 v7, v7, v55, v56
    v_max3_u32 v7, v7, v57, v58
    v_max3_u32 v7, v7, v59, v60
    v_max3_u32 v7, v7, v61, v62
    v_max3_u32 v7, v7, v63, v64
    v_max_u32 v7, v7, v65
    v_cmp_eq_u32 vcc, -1, v7
    s_nop 0
    s_cmp_lg_u64 vcc, 0
    s_cbranch_scc1 L_sa_poll
L_sa_go:
    s_and_b32 s38, s42, 1
    s_cmp_eq_u32 s38, 1
    s_cbranch_scc1 L_sa_B
    v_and_b32_dpp v20, v72, v8 row_newbcast:0 row_mask:0xf bank_mask:0xf
    v_and_b32_dpp v21, v72, v9 row_newbcast:0 row_mask:0xf bank_mask:0xf
    v_and_b32_dpp v22, v72, v10 row_newbcast:0 row_mask:0xf bank_mask:0xf
    v_and_b32_dpp v23, v72, v11 row_newbcast:0 row_mask:0xf bank_mask:0xf
    v_and_b32_dpp v24, v72, v8 row_newbcast:1 row_mask:0xf bank_mask:0xf
    v_and_b32_dpp v25, v72, v9 row_newbcast:1 row_mask:0xf bank_mask:0xf
    v_mfma_f32_16x16x32_bf16 v[28:31], v[20:23], v[96:99], 0
    v_and_b32_dpp v26, v72, v10 row_newbcast:1 row_mask:0xf bank_mask:0xf
    v_and_b32_dpp v27, v72, v11 row_newbcast:1 row_mask:0xf bank_mask:0xf
    v_mfma_f32_16x16x32_bf16 v[32:35], v[20:23], v[224:227], 0
    v_and_b32_dpp v20, v72, v8 row_newbcast:2 row_mask:0xf bank_mask:0xf
    v_and_b32_dpp v21, v72, v9 row_newbcast:2 row_mask:0xf bank_mask:0xf
    v_mfma_f32_16x16x32_bf16 v[28:31], v[24:27], v[100:103], v[28:31]
    v_and_b32_dpp v22, v72, v10 row_newbcast:2 row_mask:0xf bank_mask:0xf
    v_and_b32_dpp v23, v72, v11 row_newbcast:2 row_mask:0xf bank_mask:0xf
    v_mfma_f32_16x16x32_bf16 v[32:35], v[24:27], v[228:231], v[32:35]
    v_and_b32_dpp v24, v72, v8 row_newbcast:3 row_mask:0xf bank_mask:0xf
    v_and_b32_dpp v25, v72, v9 row_newbcast:3 row_mask:0xf bank_mask:0xf
    v_mfma_f32_16x16x32_bf16 v[28:31], v[20:23], v[104:107], v[28:31]
    v_and_b32_dpp v26, v72, v10 row_newbcast:3 row_mask:0xf bank_mask:0xf
    v_and_b32_dpp v27, v72, v11 row_newbcast:3 row_mask:0xf bank_mask:0xf
    v_mfma_f32_16x16x32_bf16 v[32:35], v[20:23], v[232:235], v[32:35]
    v_and_b32_dpp v20, v72, v8 row_newbcast:4 row_mask:0xf bank_mask:0xf
    v_and_b32_dpp v21, v72, v9 row_newbcast:4 row_mask:0xf bank_mask:0xf
    v_mfma_f32_16x16x32_bf16 v[28:31], v[24:27], v[108:111], v[28:31]
    v_and_b32_dpp v22, v72, v10 row_newbcast:4 row_mask:0xf bank_mask:0xf
    v_and_b32_dpp v23, v72, v11 row_newbcast:4 row_mask:0xf bank_mask:0xf
    v_mfma_f32_16x16x32_bf16 v[32:35], v[24:27], v[236:239], v[32:35]
    v_and_b32_dpp v24, v72, v8 row_newbcast:5 row_mask:0xf bank_mask:0xf
    v_and_b32_dpp v25, v72, v9 row_newbcast:5 row_mask:0xf bank_mask:0xf
    v_mfma_f32_16x16x32_bf16 v[28:31], v[20:23], v[112:115], v[28:31]
    v_and_b32_dpp v26, v72, v10 row_newbcast:5 row_mask:0xf bank_mask:0xf
    v_and_b32_dpp v27, v72, v11 row_newbcast:5 row_mask:0xf bank_mask:0xf
    v_mfma_f32_16x16x32_bf16 v[32:35], v[20:23], v[240:243], v[32:35]
    v_and_b32_dpp v20, v72, v8 row_newbcast:6 row_mask:0xf bank_mask:0xf
    v_and_b32_dpp v21, v72, v9 row_newbcast:6 row_mask:0xf bank_mask:0xf
    v_mfma_f32_16x16x32_bf16 v[28:31], v[24:27], v[116:119], v[28:31]
    v_and_b32_dpp v22, v72, v10 row_newbcast:6 row_mask:0xf bank_mask:0xf
    v_and_b32_dpp v23, v72, v11 row_newbcast:6 row_mask:0xf bank_mask:0xf
    v_mfma_f32_16x16x32_bf16 v[32:35], v[24:27], v[244:247], v[32:35]
    v_and_b32_dpp v24, v72, v8 row_newbcast:7 row_mask:0xf bank_mask:0xf
    v_and_b32_dpp v25, v72, v9 row_newbcast:7 row_mask:0xf bank_mask:0xf
    v_mfma_f32_16x16x32_bf16 v[28:31], v[20:23], v[120:123], v[28:31]
    v_and_b32_dpp v26, v72, v10 row_newbcast:7 row_mask:0xf bank_mask:0xf
    v_and_b32_dpp v27, v72, v11 row_newbcast:7 row_mask:0xf bank_mask:0xf
    v_mfma_f32_16x16x32_bf16 v[32:35], v[20:23], v[248:251], v[32:35]
    v_and_b32_dpp v20, v72, v8 row_newbcast:8 row_mask:0xf bank_mask:0xf
    v_and_b32_dpp v21, v72, v9 row_newbcast:8 row_mask:0xf bank_mask:0xf
    v_mfma_f32_16x16x32_bf16 v[28:31], v[24:27], v[124:127], v[28:31]
    v_and_b32_dpp v22, v72, v10 row_newbcast:8 row_mask:0xf bank_mask:0xf
    v_and_b32_dpp v23, v72, v11 row_newbcast:8 row_mask:0xf bank_mask:0xf
    v_mfma_f32_16x16x32_bf16 v[32:35], v[24:27], v[252:255], v[32:35]
    v_and_b32_dpp v24, v72, v8 row_newbcast:9 row_mask:0xf bank_mask:0xf
    v_and_b32_dpp v25, v72, v9 row_newbcast:9 row_mask:0xf bank_mask:0xf
    v_mfma_f32_16x16x32_bf16 v[28:31], v[20:23], v[128:131], v[28:31]
    v_and_b32_dpp v26, v72, v10 row_newbcast:9 row_mask:0xf bank_mask:0xf
    v_and_b32_dpp v27, v72, v11 row_newbcast:9 row_mask:0xf bank_mask:0xf
    v_mfma_f32_16x16x32_bf16 v[32:35], v[20:23], a[224:227], v[32:35]
    v_and_b32_dpp v20, v72, v8 row_newbcast:10 row_mask:0xf bank_mask:0xf
    v_and_b32_dpp v21, v72, v9 row_newbcast:10 row_mask:0xf bank_mask:0xf
    v_mfma_f32_16x16x32_bf16 v[28:31], v[24:27], v[132:135], v[28:31]
    v_and_b32_dpp v22, v72, v10 row_newbcast:10 row_mask:0xf bank_mask:0xf
    v_and_b32_dpp v23, v72, v11 row_newbcast:10 row_mask:0xf bank_mask:0xf
    v_mfma_f32_16x16x32_bf16 v[32:35], v[24:27], a[228:231], v[32:35]
    v_and_b32_dpp v24, v72, v8 row_newbcast:11 row_mask:0xf bank_mask:0xf
    v_and_b32_dpp v25, v72, v9 row_newbcast:11 row_mask:0xf bank_mask:0xf
    v_mfma_f32_16x16x32_bf16 v[28:31], v[20:23], v[136:139], v[28:31]
    v_and_b32_dpp v26, v72, v10 row_newbcast:11 row_mask:0xf bank_mask:0xf
    v_and_b32_dpp v27, v72, v11 row_newbcast:11 row_mask:0xf bank_mask:0xf
    v_mfma_f32_16x16x32_bf16 v[32:35], v[20:23], a[232:235], v[32:35]
    v_and_b32_dpp v20, v72, v8 row_newbcast:12 row_mask:0xf bank_mask:0xf
    v_and_b32_dpp v21, v72, v9 row_newbcast:12 row_mask:0xf bank_mask:0xf
    v_mfma_f32_16x16x32_bf16 v[28:31], v[24:27], v[140:143], v[28:31]
    v_and_b32_dpp v22, v72, v10 row_newbcast:12 row_mask:0xf bank_mask:0xf
    v_and_b32_dpp v23, v72, v11 row_newbcast:12 row_mask:0xf bank_mask:0xf
    v_mfma_f32_16x16x32_bf16 v[32:35], v[24:27], a[236:239], v[32:35]
    v_and_b32_dpp v24, v72, v8 row_newbcast:13 row_mask:0xf bank_mask:0xf
    v_and_b32_dpp v25, v72, v9 row_newbcast:13 row_mask:0xf bank_mask:0xf
    v_mfma_f32_16x16x32_bf16 v[28:31], v[20:23], v[144:147], v[28:31]
    v_and_b32_dpp v26, v72, v10 row_newbcast:13 row_mask:0xf bank_mask:0xf
    v_and_b32_dpp v27, v72, v11 row_newbcast:13 row_mask:0xf bank_mask:0xf
    v_mfma_f32_16x16x32_bf16 v[32:35], v[20:23], a[240:243], v[32:35]
    v_and_b32_dpp v20, v72, v8 row_newbcast:14 row_mask:0xf bank_mask:0xf
    v_and_b32_dpp v21, v72, v9 row_newbcast:14 row_mask:0xf bank_mask:0xf
    v_mfma_f32_16x16x32_bf16 v[28:31], v[24:27], v[148:151], v[28:31]
    v_and_b32_dpp v22, v72, v10 row_newbcast:14 row_mask:0xf bank_mask:0xf
    v_and_b32_dpp v23, v72, v11 row_newbcast:14 row_mask:0xf bank_mask:0xf
    v_mfma_f32_16x16x32_bf16 v[32:35], v[24:27], a[244:247], v[32:35]
    v_and_b32_dpp v24, v72, v8 row_newbcast:15 row_mask:0xf bank_mask:0xf
    v_and_b32_dpp v25, v72, v9 row_newbcast:15 row_mask:0xf bank_mask:0xf
    v_mfma_f32_16x16x32_bf16 v[28:31], v[20:23], v[152:155], v[28:31]
    v_and_b32_dpp v26, v72, v10 row_newbcast:15 row_mask:0xf bank_mask:0xf
    v_and_b32_dpp v27, v72, v11 row_newbcast:15 row_mask:0xf bank_mask:0xf
    v_mfma_f32_16x16x32_bf16 v[32:35], v[20:23], a[248:251], v[32:35]
    s_nop 0
    v_mfma_f32_16x16x32_bf16 v[28:31], v[24:27], v[156:159], v[28:31]
    v_mfma_f32_16x16x32_bf16 v[32:35], v[24:27], a[252:255], v[32:35]
    s_branch L_sa_red
L_sa_B:
    v_and_b32_dpp v20, v72, v8 row_newbcast:0 row_mask:0xf bank_mask:0xf
    v_and_b32_dpp v21, v72, v9 row_newbcast:0 row_mask:0xf bank_mask:0xf
    v_and_b32_dpp v22, v72, v10 row_newbcast:0 row_mask:0xf bank_mask:0xf
    v_and_b32_dpp v23, v72, v11 row_newbcast:0 row_mask:0xf bank_mask:0xf
    v_and_b32_dpp v24, v72, v8 row_newbcast:1 row_mask:0xf bank_mask:0xf
    v_and_b32_dpp v25, v72, v9 row_newbcast:1 row_mask:0xf bank_mask:0xf
    v_mfma_f32_16x16x32_bf16 v[28:31], v[20:23], v[160:163], 0
    v_and_b32_dpp v26, v72, v10 row_newbcast:1 row_mask:0xf bank_mask:0xf
    v_and_b32_dpp v27, v72, v11 row_newbcast:1 row_mask:0xf bank_mask:0xf
    v_mfma_f32_16x16x32_bf16 v[32:35], v[20:23], v[224:227], 0
    v_and_b32_dpp v20, v72, v8 row_newbcast:2 row_mask:0xf bank_mask:0xf
    v_and_b32_dpp v21, v72, v9 row_newbcast:2 row_mask:0xf bank_mask:0xf
    v_mfma_f32_16x16x32_bf16 v[28:31], v[24:27], v[164:167], v[28:31]
    v_and_b32_dpp v22, v72, v10 row_newbcast:2 row_mask:0xf bank_mask:0xf
    v_and_b32_dpp v23, v72, v11 row_newbcast:2 row_mask:0xf bank_mask:0xf
    v_mfma_f32_16x16x32_bf16 v[32:35], v[24:27], v[228:231], v[32:35]
    v_and_b32_dpp v24, v72, v8 row_newbcast:3 row_mask:0xf bank_mask:0xf
    v_and_b32_dpp v25, v72, v9 row_newbcast:3 row_mask:0xf bank_mask:0xf
    v_mfma_f32_16x16x32_bf16 v[28:31], v[20:23], v[168:171], v[28:31]
    v_and_b32_dpp v26, v72, v10 row_newbcast:3 row_mask:0xf bank_mask:0xf
    v_and_b32_dpp v27, v72, v11 row_newbcast:3 row_mask:0xf bank_mask:0xf
    v_mfma_f32_16x16x32_bf16 v[32:35], v[20:23], v[232:235], v[32:35]
    v_and_b32_dpp v20, v72, v8 row_newbcast:4 row_mask:0xf bank_mask:0xf
    v_and_b32_dpp v21, v72, v9 row_newbcast:4 row_mask:0xf bank_mask:0xf
    v_mfma_f32_16x16x32_bf16 v[28:31], v[24:27], v[172:175], v[28:31]
    v_and_b32_dpp v22, v72, v10 row_newbcast:4 row_mask:0xf bank_mask:0xf
    v_and_b32_dpp v23, v72, v11 row_newbcast:4 row_mask:0xf bank_mask:0xf
    v_mfma_f32_16x16x32_bf16 v[32:35], v[24:27], v[236:239], v[32:35]
    v_and_b32_dpp v24, v72, v8 row_newbcast:5 row_mask:0xf bank_mask:0xf
    v_and_b32_dpp v25, v72, v9 row_newbcast:5 row_mask:0xf bank_mask:0xf
    v_mfma_f32_16x16x32_bf16 v[28:31], v[20:23], v[176:179], v[28:31]
    v_and_b32_dpp v26, v72, v10 row_newbcast:5 row_mask:0xf bank_mask:0xf
    v_and_b32_dpp v27, v72, v11 row_newbcast:5 row_mask:0xf bank_mask:0xf
    v_mfma_f32_16x16x32_bf16 v[32:35], v[20:23], v[240:243], v[32:35]
    v_and_b32_dpp v20, v72, v8 row_newbcast:6 row_mask:0xf bank_mask:0xf
    v_and_b32_dpp v21, v72, v9 row_newbcast:6 row_mask:0xf bank_mask:0xf
    v_mfma_f32_16x16x32_bf16 v[28:31], v[24:27], v[180:183], v[28:31]
    v_and_b32_dpp v22, v72, v10 row_newbcast:6 row_mask:0xf bank_mask:0xf
    v_and_b32_dpp v23, v72, v11 row_newbcast:6 row_mask:0xf bank_mask:0xf
    v_mfma_f32_16x16x32_bf16 v[32:35], v[24:27], v[244:247], v[32:35]
    v_and_b32_dpp v24, v72, v8 row_newbcast:7 row_mask:0xf bank_mask:0xf
    v_and_b32_dpp v25, v72, v9 row_newbcast:7 row_mask:0xf bank_mask:0xf
    v_mfma_f32_16x16x32_bf16 v[28:31], v[20:23], v[184:187], v[28:31]
    v_and_b32_dpp v26, v72, v10 row_newbcast:7 row_mask:0xf bank_mask:0xf
    v_and_b32_dpp v27, v72, v11 row_newbcast:7 row_mask:0xf bank_mask:0xf
    v_mfma_f32_16x16x32_bf16 v[32:35], v[20:23], v[248:251], v[32:35]
    v_and_b32_dpp v20, v72, v8 row_newbcast:8 row_mask:0xf bank_mask:0xf
    v_and_b32_dpp v21, v72, v9 row_newbcast:8 row_mask:0xf bank_mask:0xf
    v_mfma_f32_16x16x32_bf16 v[28:31], v[24:27], v[188:191], v[28:31]
    v_and_b32_dpp v22, v72, v10 row_newbcast:8 row_mask:0xf bank_mask:0xf
    v_and_b32_dpp v23, v72, v11 row_newbcast:8 row_mask:0xf bank_mask:0xf
    v_mfma_f32_16x16x32_bf16 v[32:35], v[24:27], v[252:255], v[32:35]
    v_and_b32_dpp v24, v72, v8 row_newbcast:9 row_mask:0xf bank_mask:0xf
    v_and_b32_dpp v25, v72, v9 row_newbcast:9 row_mask:0xf bank_mask:0xf
    v_mfma_f32_16x16x32_bf16 v[28:31], v[20:23], v[192:195], v[28:31]
    v_and_b32_dpp v26, v72, v10 row_newbcast:9 row_mask:0xf bank_mask:0xf
    v_and_b32_dpp v27, v72, v11 row_newbcast:9 row_mask:0xf bank_mask:0xf
    v_mfma_f32_16x16x32_bf16 v[32:35], v[20:23], a[224:227], v[32:35]
    v_and_b32_dpp v20, v72, v8 row_newbcast:10 row_mask:0xf bank_mask:0xf
    v_and_b32_dpp v21, v72, v9 row_newbcast:10 row_mask:0xf bank_mask:0xf
    v_mfma_f32_16x16x32_bf16 v[28:31], v[24:27], v[196:199], v[28:31]
    v_and_b32_dpp v22, v72, v10 row_newbcast:10 row_mask:0xf bank_mask:0xf
    v_and_b32_dpp v23, v72, v11 row_newbcast:10 row_mask:0xf bank_mask:0xf
    v_mfma_f32_16x16x32_bf16 v[32:35], v[24:27], a[228:231], v[32:35]
    v_and_b32_dpp v24, v72, v8 row_newbcast:11 row_mask:0xf bank_mask:0xf
    v_and_b32_dpp v25, v72, v9 row_newbcast:11 row_mask:0xf bank_mask:0xf
    v_mfma_f32_16x16x32_bf16 v[28:31], v[20:23], v[200:203], v[28:31]
    v_and_b32_dpp v26, v72, v10 row_newbcast:11 row_mask:0xf bank_mask:0xf
    v_and_b32_dpp v27, v72, v11 row_newbcast:11 row_mask:0xf bank_mask:0xf
    v_mfma_f32_16x16x32_bf16 v[32:35], v[20:23], a[232:235], v[32:35]
    v_and_b32_dpp v20, v72, v8 row_newbcast:12 row_mask:0xf bank_mask:0xf
    v_and_b32_dpp v21, v72, v9 row_newbcast:12 row_mask:0xf bank_mask:0xf
    v_mfma_f32_16x16x32_bf16 v[28:31], v[24:27], v[204:207], v[28:31]
    v_and_b32_dpp v22, v72, v10 row_newbcast:12 row_mask:0xf bank_mask:0xf
    v_and_b32_dpp v23, v72, v11 row_newbcast:12 row_mask:0xf bank_mask:0xf
    v_mfma_f32_16x16x32_bf16 v[32:35], v[24:27], a[236:239], v[32:35]
    v_and_b32_dpp v24, v72, v8 row_newbcast:13 row_mask:0xf bank_mask:0xf
    v_and_b32_dpp v25, v72, v9 row_newbcast:13 row_mask:0xf bank_mask:0xf
    v_mfma_f32_16x16x32_bf16 v[28:31], v[20:23], v[208:211], v[28:31]
    v_and_b32_dpp v26, v72, v10 row_newbcast:13 row_mask:0xf bank_mask:0xf
    v_and_b32_dpp v27, v72, v11 row_newbcast:13 row_mask:0xf bank_mask:0xf
    v_mfma_f32_16x16x32_bf16 v[32:35], v[20:23], a[240:243], v[32:35]
    v_and_b32_dpp v20, v72, v8 row_newbcast:14 row_mask:0xf bank_mask:0xf
    v_and_b32_dpp v21, v72, v9 row_newbcast:14 row_mask:0xf bank_mask:0xf
    v_mfma_f32_16x16x32_bf16 v[28:31], v[24:27], v[212:215], v[28:31]
    v_and_b32_dpp v22, v72, v10 row_newbcast:14 row_mask:0xf bank_mask:0xf
    v_and_b32_dpp v23, v72, v11 row_newbcast:14 row_mask:0xf bank_mask:0xf
    v_mfma_f32_16x16x32_bf16 v[32:35], v[24:27], a[244:247], v[32:35]
    v_and_b32_dpp v24, v72, v8 row_newbcast:15 row_mask:0xf bank_mask:0xf
    v_and_b32_dpp v25, v72, v9 row_newbcast:15 row_mask:0xf bank_mask:0xf
    v_mfma_f32_16x16x32_bf16 v[28:31], v[20:23], v[216:219], v[28:31]
    v_and_b32_dpp v26, v72, v10 row_newbcast:15 row_mask:0xf bank_mask:0xf
    v_and_b32_dpp v27, v72, v11 row_newbcast:15 row_mask:0xf bank_mask:0xf
    v_mfma_f32_16x16x32_bf16 v[32:35], v[20:23], a[248:251], v[32:35]
    s_nop 0
    v_mfma_f32_16x16x32_bf16 v[28:31], v[24:27], v[220:223], v[28:31]
    v_mfma_f32_16x16x32_bf16 v[32:35], v[24:27], a[252:255], v[32:35]
L_sa_red:
    s_lshl_b32 s38, s3, 10
    v_add_u32 v7, s38, v16
    s_mov_b32 exec_lo, 0
    s_nop 5
    v_mov_b32 v28, v32
    v_mov_b32 v29, v33
    v_mov_b32 v30, v34
    v_mov_b32 v31, v35
    s_mov_b32 exec_lo, -1
    s_cmp_eq_u32 s3, 0
    s_cbranch_scc1 L_sa_w0
    ds_write_b128 v7, v[28:31]
    s_waitcnt lgkmcnt(0)
    s_barrier
    s_sleep 10
    s_branch L_sb
L_sa_w0:
    s_barrier
    ds_read_b128 v[40:43], v16 offset:1024
    ds_read_b128 v[44:47], v16 offset:2048
    ds_read_b128 v[48:51], v16 offset:3072
    s_waitcnt lgkmcnt(2)
    v_pk_add_f32 v[28:29], v[28:29], v[40:41]
    v_pk_add_f32 v[30:31], v[30:31], v[42:43]
    s_waitcnt lgkmcnt(1)
    v_pk_add_f32 v[28:29], v[28:29], v[44:45]
    v_pk_add_f32 v[30:31], v[30:31], v[46:47]
    s_waitcnt lgkmcnt(0)
    v_pk_add_f32 v[28:29], v[28:29], v[48:49]
    v_pk_add_f32 v[30:31], v[30:31], v[50:51]
    v_min_u32 v28, -2, v28
    v_min_u32 v29, -2, v29
    v_min_u32 v30, -2, v30
    v_min_u32 v31, -2, v31
    buffer_store_dwordx4 v[28:31], v15, s[20:23], s50 offen sc1
    s_sleep 8
L_sb:
    s_cmp_eq_u32 s42, 3
    s_cbranch_scc0 L_sb_go0
    s_cmp_eq_u32 s49, 0
    s_cbranch_scc0 L_fin
L_sb_go0:
    buffer_load_dwordx4 v[36:39], v6, s[20:23], s52 offen sc1
    buffer_load_dwordx4 v[40:43], v6, s[20:23], s53 offen sc1
    buffer_load_dwordx4 v[44:47], v6, s[20:23], s54 offen sc1
    buffer_load_dwordx4 v[48:51], v6, s[20:23], s55 offen sc1
    buffer_load_dwordx4 v[52:55], v6, s[20:23], s56 offen sc1
    buffer_load_dwordx4 v[56:59], v6, s[20:23], s57 offen sc1
    buffer_load_dwordx4 v[60:63], v6, s[20:23], s58 offen sc1
    buffer_load_dwordx4 v[64:67], v6, s[20:23], s59 offen sc1
L_sb_poll:
    s_waitcnt vmcnt(6)
    v_pk_add_f32 v[68:69], v[36:37], v[40:41]
    v_pk_add_f32 v[70:71], v[38:39], v[42:43]
    s_waitcnt vmcnt(4)
    v_pk_add_f32 v[72:73], v[44:45], v[48:49]
    v_pk_add_f32 v[74:75], v[46:47], v[50:51]
    v_pk_add_f32 v[68:69], v[68:69], v[72:73]
    v_pk_add_f32 v[70:71], v[70:71], v[74:75]
    s_waitcnt vmcnt(2)
    v_pk_add_f32 v[76:77], v[52:53], v[56:57]
    v_pk_add_f32 v[78:79], v[54:55], v[58:59]
    s_waitcnt vmcnt(0)
    v_pk_add_f32 v[80:81], v[60:61], v[64:65]
    v_pk_add_f32 v[82:83], v[62:63], v[66:67]
    v_pk_add_f32 v[76:77], v[76:77], v[80:81]
    v_pk_add_f32 v[78:79], v[78:79], v[82:83]
    v_pk_add_f32 v[68:69], v[68:69], v[76:77]
    v_pk_add_f32 v[70:71], v[70:71], v[78:79]
    s_nop 1
    v_permlane32_swap_b32 v68, v70
    v_permlane32_swap_b32 v69, v71
    v_pk_add_f32 v[68:69], v[68:69], v[70:71]
    v_cmp_u_f32 vcc, v68, v69
    v_cvt_pk_bf16_f32 v68, 0, v68
    v_cvt_pk_bf16_f32 v69, 0, v69
    s_cmp_lg_u64 vcc, 0
    s_cbranch_scc0 L_sb_go
    s_cmp_eq_u32 s43, 0
    s_cbranch_scc1 L_sb_go
    s_sub_u32 s43, s43, 1
    s_mov_b32 s38, 0
    v_max3_u32 v7, v36, v37, v38
    v_max_u32 v7, v7, v39
    v_cmp_eq_u32 vcc, -1, v7
    s_nop 0
    s_cmp_lg_u64 vcc, 0
    s_cbranch_scc0 L_ysk_31
    buffer_load_dwordx4 v[36:39], v6, s[20:23], s52 offen sc1
    s_mov_b32 s38, 1
L_ysk_31:
    v_max3_u32 v7, v40, v41, v42
    v_max_u32 v7, v7, v43
    v_cmp_eq_u32 vcc, -1, v7
    s_nop 0
    s_cmp_lg_u64 vcc, 0
    s_cbranch_scc0 L_ysk_32
    buffer_load_dwordx4 v[40:43], v6, s[20:23], s53 offen sc1
    s_mov_b32 s38, 1
L_ysk_32:
    v_max3_u32 v7, v44, v45, v46
    v_max_u32 v7, v7, v47
    v_cmp_eq_u32 vcc, -1, v7
    s_nop 0
    s_cmp_lg_u64 vcc, 0
    s_cbranch_scc0 L_ysk_33
    buffer_load_dwordx4 v[44:47], v6, s[20:23], s54 offen sc1
    s_mov_b32 s38, 1
L_ysk_33:
    v_max3_u32 v7, v48, v49, v50
    v_max_u32 v7, v7, v51
    v_cmp_eq_u32 vcc, -1, v7
    s_nop 0
    s_cmp_lg_u64 vcc, 0
    s_cbranch_scc0 L_ysk_34
    buffer_load_dwordx4 v[48:51], v6, s[20:23], s55 offen sc1
    s_mov_b32 s38, 1
L_ysk_34:
    v_max3_u32 v7, v52, v53, v54
    v_max_u32 v7, v7, v55
    v_cmp_eq_u32 vcc, -1, v7
    s_nop 0
    s_cmp_lg_u64 vcc, 0
    s_cbranch_scc0 L_ysk_35
    buffer_load_dwordx4 v[52:55], v6, s[20:23], s56 offen sc1
    s_mov_b32 s38, 1
L_ysk_35:
    v_max3_u32 v7, v56, v57, v58
    v_max_u32 v7, v7, v59
    v_cmp_eq_u32 vcc, -1, v7
    s_nop 0
    s_cmp_lg_u64 vcc, 0
    s_cbranch_scc0 L_ysk_36
    buffer_load_dwordx4 v[56:59], v6, s[20:23], s57 offen sc1
    s_mov_b32 s38, 1
L_ysk_36:
    v_max3_u32 v7, v60, v61, v62
    v_max_u32 v7, v7, v63
    v_cmp_eq_u32 vcc, -1, v7
    s_nop 0
    s_cmp_lg_u64 vcc, 0
    s_cbranch_scc0 L_ysk_37
    buffer_load_dwordx4 v[60:63], v6, s[20:23], s58 offen sc1
    s_mov_b32 s38, 1
L_ysk_37:
    v_max3_u32 v7, v64, v65, v66
    v_max_u32 v7, v7, v67
    v_cmp_eq_u32 vcc, -1, v7
    s_nop 0
    s_cmp_lg_u64 vcc, 0
    s_cbranch_scc0 L_ysk_38
    buffer_load_dwordx4 v[64:67], v6, s[20:23], s59 offen sc1
    s_mov_b32 s38, 1
L_ysk_38:
    s_waitcnt vmcnt(0)
    s_cmp_eq_u32 s38, 1
    s_cbranch_scc1 L_sb_poll
L_sb_go:
    v_pk_add_f32 v[12:13], v[12:13], v[68:69]
    v_cvt_pk_bf16_f32 v68, v12, v13
    s_cmp_eq_u32 s42, 3
    s_cbranch_scc1 L_ch_out
    ds_write_b32 v17, v68
    v_and_b32 v13, 0xffff0000, v68
    v_lshlrev_b32 v12, 16, v68
    s_add_u32 s42, s42, 1
    s_add_u32 s45, s45, 458752
    s_add_u32 s46, s46, 65536
    s_add_u32 s47, s47, 32768
    s_add_u32 s50, s50, 32768
    s_add_u32 s51, s51, 8192
    s_waitcnt lgkmcnt(0)
    s_barrier
L_ch_qp:
    ds_read_b128 v[36:39], v18
    ds_read_b128 v[20:23], v19
    ds_read_b128 v[40:43], v18 offset:64
    ds_read_b128 v[44:47], v18 offset:128
    ds_read_b128 v[48:51], v18 offset:192
    ds_read_b128 v[52:55], v18 offset:256
    ds_read_b128 v[56:59], v18 offset:320
    ds_read_b128 v[60:63], v18 offset:384
    ds_read_b128 v[64:67], v18 offset:448
    ds_read_b128 v[68:71], v18 offset:512
    ds_read_b128 v[72:75], v18 offset:576
    ds_read_b128 v[76:79], v18 offset:640
    ds_read_b128 v[80:83], v18 offset:704
    ds_read_b128 v[84:87], v18 offset:768
    ds_read_b128 v[88:91], v18 offset:832
    s_and_b32 s39, s42, 1
    s_cmp_eq_u32 s39, 1
    s_cbranch_scc1 L_qp_B
    s_waitcnt lgkmcnt(13)
    v_mfma_f32_16x16x32_bf16 v[28:31], v[36:39], a[0:3], 0
    v_readfirstlane_b32 s38, v36
    s_lshl_b32 s38, s38, 16
    v_lshlrev_b32 v26, 16, v20
    v_mfma_f32_16x16x32_bf16 v[32:35], v[36:39], a[4:7], 0
    v_and_b32 v27, 0xffff0000, v20
    v_subrev_f32 v26, s38, v26
    v_subrev_f32 v27, s38, v27
    s_waitcnt lgkmcnt(12)
    v_mfma_f32_16x16x32_bf16 v[28:31], v[40:43], a[8:11], v[28:31]
    v_add_f32 v24, v26, v27
    v_mul_f32 v25, v26, v26
    v_fmac_f32 v25, v27, v27
    v_mfma_f32_16x16x32_bf16 v[32:35], v[40:43], a[12:15], v[32:35]
    v_lshlrev_b32 v26, 16, v21
    v_and_b32 v27, 0xffff0000, v21
    s_waitcnt lgkmcnt(11)
    v_mfma_f32_16x16x32_bf16 v[28:31], v[44:47], a[16:19], v[28:31]
    v_subrev_f32 v26, s38, v26
    v_subrev_f32 v27, s38, v27
    v_add_f32 v24, v24, v26
    v_mfma_f32_16x16x32_bf16 v[32:35], v[44:47], a[20:23], v[32:35]
    v_fmac_f32 v25, v26, v26
    v_add_f32 v24, v24, v27
    v_fmac_f32 v25, v27, v27
    s_waitcnt lgkmcnt(10)
    v_mfma_f32_16x16x32_bf16 v[28:31], v[48:51], a[24:27], v[28:31]
    v_lshlrev_b32 v26, 16, v22
    v_and_b32 v27, 0xffff0000, v22
    v_subrev_f32 v26, s38, v26
    v_mfma_f32_16x16x32_bf16 v[32:35], v[48:51], a[28:31], v[32:35]
    v_subrev_f32 v27, s38, v27
    v_add_f32 v24, v24, v26
    s_waitcnt lgkmcnt(9)
    v_mfma_f32_16x16x32_bf16 v[28:31], v[52:55], a[32:35], v[28:31]
    v_fmac_f32 v25, v26, v26
    v_add_f32 v24, v24, v27
    v_fmac_f32 v25, v27, v27
    v_mfma_f32_16x16x32_bf16 v[32:35], v[52:55], a[36:39], v[32:35]
    v_lshlrev_b32 v26, 16, v23
    v_and_b32 v27, 0xffff0000, v23
    v_subrev_f32 v26, s38, v26
    s_waitcnt lgkmcnt(8)
    v_mfma_f32_16x16x32_bf16 v[28:31], v[56:59], a[40:43], v[28:31]
    v_subrev_f32 v27, s38, v27
    v_add_f32 v24, v24, v26
    v_fmac_f32 v25, v26, v26
    v_mfma_f32_16x16x32_bf16 v[32:35], v[56:59], a[44:47], v[32:35]
    v_add_f32 v24, v24, v27
    v_fmac_f32 v25, v27, v27
    s_waitcnt lgkmcnt(7)
    v_mfma_f32_16x16x32_bf16 v[28:31], v[60:63], a[48:51], v[28:31]
    v_mul_f32 v24, v24, v95
    v_mul_f32 v25, v25, v95
    s_nop 0
    v_mfma_f32_16x16x32_bf16 v[32:35], v[60:63], a[52:55], v[32:35]
    v_add_f32_dpp v24, v24, v24 quad_perm:[1,0,3,2] row_mask:0xf bank_mask:0xf
    v_add_f32_dpp v25, v25, v25 quad_perm:[1,0,3,2] row_mask:0xf bank_mask:0xf
    s_nop 0
    s_waitcnt lgkmcnt(6)
    v_mfma_f32_16x16x32_bf16 v[28:31], v[64:67], a[56:59], v[28:31]
    v_add_f32_dpp v24, v24, v24 quad_perm:[2,3,0,1] row_mask:0xf bank_mask:0xf
    v_add_f32_dpp v25, v25, v25 quad_perm:[2,3,0,1] row_mask:0xf bank_mask:0xf
    s_nop 0
    v_mfma_f32_16x16x32_bf16 v[32:35], v[64:67], a[60:63], v[32:35]
    v_add_f32_dpp v24, v24, v24 row_half_mirror row_mask:0xf bank_mask:0xf
    v_add_f32_dpp v25, v25, v25 row_half_mirror row_mask:0xf bank_mask:0xf
    s_waitcnt lgkmcnt(5)
    v_mfma_f32_16x16x32_bf16 v[28:31], v[68:71], a[64:67], v[28:31]
    s_nop 0
    v_add_f32_dpp v24, v24, v24 row_mirror row_mask:0xf bank_mask:0xf
    v_add_f32_dpp v25, v25, v25 row_mirror row_mask:0xf bank_mask:0xf
    v_mfma_f32_16x16x32_bf16 v[32:35], v[68:71], a[68:71], v[32:35]
    v_mov_b32 v26, v24
    v_mov_b32 v27, v25
    s_nop 1
    s_waitcnt lgkmcnt(4)
    v_mfma_f32_16x16x32_bf16 v[28:31], v[72:75], a[72:75], v[28:31]
    v_permlane32_swap_b32 v24, v26
    v_permlane32_swap_b32 v25, v27
    v_add_f32 v24, v24, v26
    v_mfma_f32_16x16x32_bf16 v[32:35], v[72:75], a[76:79], v[32:35]
    v_add_f32 v25, v25, v27
    v_mov_b32 v26, v24
    s_waitcnt lgkmcnt(3)
    v_mfma_f32_16x16x32_bf16 v[28:31], v[76:79], a[80:83], v[28:31]
    v_mov_b32 v27, v25
    s_nop 1
    v_permlane16_swap_b32 v24, v26
    v_mfma_f32_16x16x32_bf16 v[32:35], v[76:79], a[84:87], v[32:35]
    v_permlane16_swap_b32 v25, v27
    v_add_f32 v24, v24, v26
    v_add_f32 v25, v25, v27
    s_waitcnt lgkmcnt(2)
    v_mfma_f32_16x16x32_bf16 v[28:31], v[80:83], a[88:91], v[28:31]
    v_mul_f32 v24, 991054117, v24
    v_mul_f32 v25, 991054117, v25
    v_fma_f32 v25, -v24, v24, v25
    v_mfma_f32_16x16x32_bf16 v[32:35], v[80:83], a[92:95], v[32:35]
    v_max_f32 v25, 0, v25
    v_add_f32 v24, s38, v24
    s_waitcnt lgkmcnt(1)
    v_mfma_f32_16x16x32_bf16 v[28:31], v[84:87], a[96:99], v[28:31]
    v_cvt_pk_bf16_f32 v25, 0, v25
    v_cvt_pk_bf16_f32 v24, 0, v24
    v_add_f32 v25, 925353388, v25
    v_mfma_f32_16x16x32_bf16 v[32:35], v[84:87], a[100:103], v[32:35]
    v_cvt_pk_bf16_f32 v25, 0, v25
    v_sqrt_f32 v25, v25
    s_nop 0
    s_waitcnt lgkmcnt(0)
    v_mfma_f32_16x16x32_bf16 v[28:31], v[88:91], a[104:107], v[28:31]
    v_cvt_pk_bf16_f32 v25, 0, v25
    v_rcp_f32 v25, v25
    v_mfma_f32_16x16x32_bf16 v[32:35], v[88:91], a[108:111], v[32:35]
    v_mul_f32 v24, v24, v92
    s_branch L_qp_red
L_qp_B:
    s_waitcnt lgkmcnt(13)
    v_mfma_f32_16x16x32_bf16 v[28:31], v[36:39], a[112:115], 0
    v_readfirstlane_b32 s38, v36
    s_lshl_b32 s38, s38, 16
    v_lshlrev_b32 v26, 16, v20
    v_mfma_f32_16x16x32_bf16 v[32:35], v[36:39], a[116:119], 0
    v_and_b32 v27, 0xffff0000, v20
    v_subrev_f32 v26, s38, v26
    v_subrev_f32 v27, s38, v27
    s_waitcnt lgkmcnt(12)
    v_mfma_f32_16x16x32_bf16 v[28:31], v[40:43], a[120:123], v[28:31]
    v_add_f32 v24, v26, v27
    v_mul_f32 v25, v26, v26
    v_fmac_f32 v25, v27, v27
    v_mfma_f32_16x16x32_bf16 v[32:35], v[40:43], a[124:127], v[32:35]
    v_lshlrev_b32 v26, 16, v21
    v_and_b32 v27, 0xffff0000, v21
    s_waitcnt lgkmcnt(11)
    v_mfma_f32_16x16x32_bf16 v[28:31], v[44:47], a[128:131], v[28:31]
    v_subrev_f32 v26, s38, v26
    v_subrev_f32 v27, s38, v27
    v_add_f32 v24, v24, v26
    v_mfma_f32_16x16x32_bf16 v[32:35], v[44:47], a[132:135], v[32:35]
    v_fmac_f32 v25, v26, v26
    v_add_f32 v24, v24, v27
    v_fmac_f32 v25, v27, v27
    s_waitcnt lgkmcnt(10)
    v_mfma_f32_16x16x32_bf16 v[28:31], v[48:51], a[136:139], v[28:31]
    v_lshlrev_b32 v26, 16, v22
    v_and_b32 v27, 0xffff0000, v22
    v_subrev_f32 v26, s38, v26
    v_mfma_f32_16x16x32_bf16 v[32:35], v[48:51], a[140:143], v[32:35]
    v_subrev_f32 v27, s38, v27
    v_add_f32 v24, v24, v26
    s_waitcnt lgkmcnt(9)
    v_mfma_f32_16x16x32_bf16 v[28:31], v[52:55], a[144:147], v[28:31]
    v_fmac_f32 v25, v26, v26
    v_add_f32 v24, v24, v27
    v_fmac_f32 v25, v27, v27
    v_mfma_f32_16x16x32_bf16 v[32:35], v[52:55], a[148:151], v[32:35]
    v_lshlrev_b32 v26, 16, v23
    v_and_b32 v27, 0xffff0000, v23
    v_subrev_f32 v26, s38, v26
    s_waitcnt lgkmcnt(8)
    v_mfma_f32_16x16x32_bf16 v[28:31], v[56:59], a[152:155], v[28:31]
    v_subrev_f32 v27, s38, v27
    v_add_f32 v24, v24, v26
    v_fmac_f32 v25, v26, v26
    v_mfma_f32_16x16x32_bf16 v[32:35], v[56:59], a[156:159], v[32:35]
    v_add_f32 v24, v24, v27
    v_fmac_f32 v25, v27, v27
    s_waitcnt lgkmcnt(7)
    v_mfma_f32_16x16x32_bf16 v[28:31], v[60:63], a[160:163], v[28:31]
    v_mul_f32 v24, v24, v95
    v_mul_f32 v25, v25, v95
    s_nop 0
    v_mfma_f32_16x16x32_bf16 v[32:35], v[60:63], a[164:167], v[32:35]
    v_add_f32_dpp v24, v24, v24 quad_perm:[1,0,3,2] row_mask:0xf bank_mask:0xf
    v_add_f32_dpp v25, v25, v25 quad_perm:[1,0,3,2] row_mask:0xf bank_mask:0xf
    s_nop 0
    s_waitcnt lgkmcnt(6)
    v_mfma_f32_16x16x32_bf16 v[28:31], v[64:67], a[168:171], v[28:31]
    v_add_f32_dpp v24, v24, v24 quad_perm:[2,3,0,1] row_mask:0xf bank_mask:0xf
    v_add_f32_dpp v25, v25, v25 quad_perm:[2,3,0,1] row_mask:0xf bank_mask:0xf
    s_nop 0
    v_mfma_f32_16x16x32_bf16 v[32:35], v[64:67], a[172:175], v[32:35]
    v_add_f32_dpp v24, v24, v24 row_half_mirror row_mask:0xf bank_mask:0xf
    v_add_f32_dpp v25, v25, v25 row_half_mirror row_mask:0xf bank_mask:0xf
    s_waitcnt lgkmcnt(5)
    v_mfma_f32_16x16x32_bf16 v[28:31], v[68:71], a[176:179], v[28:31]
    s_nop 0
    v_add_f32_dpp v24, v24, v24 row_mirror row_mask:0xf bank_mask:0xf
    v_add_f32_dpp v25, v25, v25 row_mirror row_mask:0xf bank_mask:0xf
    v_mfma_f32_16x16x32_bf16 v[32:35], v[68:71], a[180:183], v[32:35]
    v_mov_b32 v26, v24
    v_mov_b32 v27, v25
    s_nop 1
    s_waitcnt lgkmcnt(4)
    v_mfma_f32_16x16x32_bf16 v[28:31], v[72:75], a[184:187], v[28:31]
    v_permlane32_swap_b32 v24, v26
    v_permlane32_swap_b32 v25, v27
    v_add_f32 v24, v24, v26
    v_mfma_f32_16x16x32_bf16 v[32:35], v[72:75], a[188:191], v[32:35]
    v_add_f32 v25, v25, v27
    v_mov_b32 v26, v24
    s_waitcnt lgkmcnt(3)
    v_mfma_f32_16x16x32_bf16 v[28:31], v[76:79], a[192:195], v[28:31]
    v_mov_b32 v27, v25
    s_nop 1
    v_permlane16_swap_b32 v24, v26
    v_mfma_f32_16x16x32_bf16 v[32:35], v[76:79], a[196:199], v[32:35]
    v_permlane16_swap_b32 v25, v27
    v_add_f32 v24, v24, v26
    v_add_f32 v25, v25, v27
    s_waitcnt lgkmcnt(2)
    v_mfma_f32_16x16x32_bf16 v[28:31], v[80:83], a[200:203], v[28:31]
    v_mul_f32 v24, 991054117, v24
    v_mul_f32 v25, 991054117, v25
    v_fma_f32 v25, -v24, v24, v25
    v_mfma_f32_16x16x32_bf16 v[32:35], v[80:83], a[204:207], v[32:35]
    v_max_f32 v25, 0, v25
    v_add_f32 v24, s38, v24
    s_waitcnt lgkmcnt(1)
    v_mfma_f32_16x16x32_bf16 v[28:31], v[84:87], a[208:211], v[28:31]
    v_cvt_pk_bf16_f32 v25, 0, v25
    v_cvt_pk_bf16_f32 v24, 0, v24
    v_add_f32 v25, 925353388, v25
    v_mfma_f32_16x16x32_bf16 v[32:35], v[84:87], a[212:215], v[32:35]
    v_cvt_pk_bf16_f32 v25, 0, v25
    v_sqrt_f32 v25, v25
    s_nop 0
    s_waitcnt lgkmcnt(0)
    v_mfma_f32_16x16x32_bf16 v[28:31], v[88:91], a[216:219], v[28:31]
    v_cvt_pk_bf16_f32 v25, 0, v25
    v_rcp_f32 v25, v25
    v_mfma_f32_16x16x32_bf16 v[32:35], v[88:91], a[220:223], v[32:35]
    v_mul_f32 v24, v24, v93
L_qp_red:
    s_nop 5
    v_mov_b32 v26, v28
    s_mov_b32 exec_lo, 0xffff0000
    s_mov_b32 exec_hi, 0xffff0000
    v_mov_b32 v26, v32
    s_mov_b64 exec, -1
    v_sub_f32 v26, v26, v24
    v_mul_f32 v26, v26, v25
    s_nop 1
    v_mov_b32_dpp v27, v26 quad_perm:[1,1,3,3] row_mask:0xf bank_mask:0xf
    v_cvt_pk_bf16_f32 v26, v26, v27
    v_min_u32 v26, -2, v26
    s_mov_b32 exec_lo, 0x55555555
    s_mov_b32 exec_hi, 0
    s_cmp_eq_u32 s35, 1
    s_cbranch_scc0 L_qp_far
    buffer_store_dword v26, v94, s[20:23], s51 offen
    s_branch L_qp_st
L_qp_far:
    buffer_store_dword v26, v94, s[20:23], s51 offen sc1
L_qp_st:
    s_mov_b64 exec, -1
    s_cmp_eq_u32 s42, 0
    s_cbranch_scc0 L_ch_stageA
    s_barrier
    s_lshl_b32 s38, s3, 15
    s_lshl_b32 s39, s49, 8
    s_add_u32 s38, s38, s39
    s_lshl_b32 s40, s3, 10
    s_add_u32 s39, s38, 0
    s_add_u32 s41, s40, 0
    s_mov_b32 m0, s41
    s_nop 0
    buffer_load_dwordx4 v1, s[12:15], s39 offen nt lds
    s_add_u32 s39, s38, 131072
    s_add_u32 s41, s40, 4096
    s_mov_b32 m0, s41
    s_nop 0
    buffer_load_dwordx4 v1, s[12:15], s39 offen nt lds
    s_add_u32 s39, s38, 262144
    s_add_u32 s41, s40, 8192
    s_mov_b32 m0, s41
    s_nop 0
    buffer_load_dwordx4 v1, s[12:15], s39 offen nt lds
    s_add_u32 s39, s38, 393216
    s_add_u32 s41, s40, 12288
    s_mov_b32 m0, s41
    s_nop 0
    buffer_load_dwordx4 v1, s[12:15], s39 offen nt lds
    s_add_u32 s39, s38, 524288
    s_add_u32 s41, s40, 16384
    s_mov_b32 m0, s41
    s_nop 0
    buffer_load_dwordx4 v1, s[12:15], s39 offen nt lds
    s_add_u32 s39, s38, 655360
    s_add_u32 s41, s40, 20480
    s_mov_b32 m0, s41
    s_nop 0
    buffer_load_dwordx4 v1, s[12:15], s39 offen nt lds
    s_add_u32 s39, s38, 786432
    s_add_u32 s41, s40, 24576
    s_mov_b32 m0, s41
    s_nop 0
    buffer_load_dwordx4 v1, s[12:15], s39 offen nt lds
    s_add_u32 s39, s38, 917504
    s_add_u32 s41, s40, 28672
    s_mov_b32 m0, s41
    s_nop 0
    buffer_load_dwordx4 v1, s[12:15], s39 offen nt lds
    s_add_u32 s39, s38, 1048576
    s_add_u32 s41, s40, 32768
    s_mov_b32 m0, s41
    s_nop 0
    buffer_load_dwordx4 v1, s[12:15], s39 offen nt lds
    s_add_u32 s39, s38, 1179648
    s_add_u32 s41, s40, 36864
    s_mov_b32 m0, s41
    s_nop 0
    buffer_load_dwordx4 v1, s[12:15], s39 offen nt lds
    s_add_u32 s39, s38, 1310720
    s_add_u32 s41, s40, 40960
    s_mov_b32 m0, s41
    s_nop 0
    buffer_load_dwordx4 v1, s[12:15], s39 offen nt lds
    s_add_u32 s39, s38, 1441792
    s_add_u32 s41, s40, 45056
    s_mov_b32 m0, s41
    s_nop 0
    buffer_load_dwordx4 v1, s[12:15], s39 offen nt lds
    s_add_u32 s39, s38, 1572864
    s_add_u32 s41, s40, 49152
    s_mov_b32 m0, s41
    s_nop 0
    buffer_load_dwordx4 v1, s[12:15], s39 offen nt lds
    s_add_u32 s39, s38, 1703936
    s_add_u32 s41, s40, 53248
    s_mov_b32 m0, s41
    s_nop 0
    buffer_load_dwordx4 v1, s[12:15], s39 offen nt lds
    s_add_u32 s39, s38, 1835008
    s_add_u32 s41, s40, 57344
    s_mov_b32 m0, s41
    s_nop 0
    buffer_load_dwordx4 v1, s[12:15], s39 offen nt lds
    s_add_u32 s39, s38, 1966080
    s_add_u32 s41, s40, 61440
    s_mov_b32 m0, s41
    s_nop 0
    buffer_load_dwordx4 v1, s[12:15], s39 offen nt lds
    s_add_u32 s39, s38, 2097152
    s_add_u32 s41, s40, 65536
    s_mov_b32 m0, s41
    s_nop 0
    buffer_load_dwordx4 v1, s[12:15], s39 offen nt lds
    s_add_u32 s39, s38, 2228224
    s_add_u32 s41, s40, 69632
    s_mov_b32 m0, s41
    s_nop 0
    buffer_load_dwordx4 v1, s[12:15], s39 offen nt lds
    s_add_u32 s39, s38, 2359296
    s_add_u32 s41, s40, 73728
    s_mov_b32 m0, s41
    s_nop 0
    buffer_load_dwordx4 v1, s[12:15], s39 offen nt lds
    s_add_u32 s39, s38, 2490368
    s_add_u32 s41, s40, 77824
    s_mov_b32 m0, s41
    s_nop 0
    buffer_load_dwordx4 v1, s[12:15], s39 offen nt lds
    s_add_u32 s39, s38, 2621440
    s_add_u32 s41, s40, 81920
    s_mov_b32 m0, s41
    s_nop 0
    buffer_load_dwordx4 v1, s[12:15], s39 offen nt lds
    s_add_u32 s39, s38, 2752512
    s_add_u32 s41, s40, 86016
    s_mov_b32 m0, s41
    s_nop 0
    buffer_load_dwordx4 v1, s[12:15], s39 offen nt lds
    s_add_u32 s39, s38, 2883584
    s_add_u32 s41, s40, 90112
    s_mov_b32 m0, s41
    s_nop 0
    buffer_load_dwordx4 v1, s[12:15], s39 offen nt lds
    s_add_u32 s39, s38, 3014656
    s_add_u32 s41, s40, 94208
    s_mov_b32 m0, s41
    s_nop 0
    buffer_load_dwordx4 v1, s[12:15], s39 offen nt lds
    s_add_u32 s39, s38, 3145728
    s_add_u32 s41, s40, 98304
    s_mov_b32 m0, s41
    s_nop 0
    buffer_load_dwordx4 v1, s[12:15], s39 offen nt lds
    s_add_u32 s39, s38, 3276800
    s_add_u32 s41, s40, 102400
    s_mov_b32 m0, s41
    s_nop 0
    buffer_load_dwordx4 v1, s[12:15], s39 offen nt lds
    s_add_u32 s39, s38, 3407872
    s_add_u32 s41, s40, 106496
    s_mov_b32 m0, s41
    s_nop 0
    buffer_load_dwordx4 v1, s[12:15], s39 offen nt lds
    s_add_u32 s39, s38, 3538944
    s_add_u32 s41, s40, 110592
    s_mov_b32 m0, s41
    s_nop 0
    buffer_load_dwordx4 v1, s[12:15], s39 offen nt lds
    s_and_b32 s39, s49, 1
    s_lshl_b32 s39, s39, 7
    s_not_b32 s39, s39
    v_lshlrev_b32 v91, 4, v0
    v_and_b32 v91, 0xf0, v91
    v_sub_u32 v7, v2, v91
    v_and_b32 v91, s39, v91
    v_add_u32 v91, v91, v7
    s_lshr_b32 s38, s49, 1
    s_lshl_b32 s38, s38, 2
    s_add_u32 s38, s38, s3
    s_mul_i32 s38, s38, 57344
    s_and_b32 s39, s49, 1
    s_lshl_b32 s39, s39, 9
    s_add_u32 s38, s38, s39
    s_add_u32 s39, s38, 256
    buffer_load_dwordx4 v[224:227], v91, s[8:11], s39 offen nt
    s_add_u32 s39, s38, 3840
    buffer_load_dwordx4 v[228:231], v91, s[8:11], s39 offen nt
    s_add_u32 s39, s38, 7424
    buffer_load_dwordx4 v[232:235], v91, s[8:11], s39 offen nt
    s_add_u32 s39, s38, 11008
    buffer_load_dwordx4 v[236:239], v91, s[8:11], s39 offen nt
    s_add_u32 s39, s38, 14592
    buffer_load_dwordx4 v[240:243], v91, s[8:11], s39 offen nt
    s_add_u32 s39, s38, 18176
    buffer_load_dwordx4 v[244:247], v91, s[8:11], s39 offen nt
    s_add_u32 s39, s38, 21760
    buffer_load_dwordx4 v[248:251], v91, s[8:11], s39 offen nt
    s_add_u32 s39, s38, 25344
    buffer_load_dwordx4 v[252:255], v91, s[8:11], s39 offen nt
    s_add_u32 s39, s38, 28928
    buffer_load_dwordx4 a[224:227], v91, s[8:11], s39 offen nt
    s_add_u32 s39, s38, 32512
    buffer_load_dwordx4 a[228:231], v91, s[8:11], s39 offen nt
    s_add_u32 s39, s38, 36096
    buffer_load_dwordx4 a[232:235], v91, s[8:11], s39 offen nt
    s_add_u32 s39, s38, 39680
    buffer_load_dwordx4 a[236:239], v91, s[8:11], s39 offen nt
    s_add_u32 s39, s38, 43264
    buffer_load_dwordx4 a[240:243], v91, s[8:11], s39 offen nt
    s_add_u32 s39, s38, 46848
    buffer_load_dwordx4 a[244:247], v91, s[8:11], s39 offen nt
    s_add_u32 s39, s38, 50432
    buffer_load_dwordx4 a[248:251], v91, s[8:11], s39 offen nt
    s_add_u32 s39, s38, 54016
    buffer_load_dwordx4 a[252:255], v91, s[8:11], s39 offen nt
    s_waitcnt vmcnt(16)
    s_barrier
    v_lshrrev_b32 v20, 4, v0
    v_bfe_u32 v21, v0, 2, 2
    v_and_b32 v22, 1, v20
    v_lshl_add_u32 v22, v22, 2, v21
    s_lshl_b32 s38, s3, 1
    v_xor_b32 v22, s38, v22
    v_lshlrev_b32 v22, 5, v22
    v_lshl_add_u32 v20, v20, 3, v21
    v_lshl_add_u32 v20, v20, 8, v22
    v_and_b32 v21, 3, v0
    v_lshl_add_u32 v20, v21, 3, v20
    v_xor_b32 v21, 32, v20
    v_add_u32 v22, 57344, v20
    v_add_u32 v23, 57344, v21
    ds_read_b64_tr_b16 a[112:113], v20 offset:0
    ds_read_b64_tr_b16 a[114:115], v20 offset:1024
    ds_read_b64_tr_b16 a[116:117], v21 offset:0
    ds_read_b64_tr_b16 a[118:119], v21 offset:1024
    ds_read_b64_tr_b16 a[120:121], v20 offset:8192
    ds_read_b64_tr_b16 a[122:123], v20 offset:9216
    ds_read_b64_tr_b16 a[124:125], v21 offset:8192
    ds_read_b64_tr_b16 a[126:127], v21 offset:9216
    ds_read_b64_tr_b16 a[128:129], v20 offset:16384
    ds_read_b64_tr_b16 a[130:131], v20 offset:17408
    ds_read_b64_tr_b16 a[132:133], v21 offset:16384
    ds_read_b64_tr_b16 a[134:135], v21 offset:17408
    s_waitcnt lgkmcnt(3)
    ds_read_b64_tr_b16 a[136:137], v20 offset:24576
    ds_read_b64_tr_b16 a[138:139], v20 offset:25600
    ds_read_b64_tr_b16 a[140:141], v21 offset:24576
    ds_read_b64_tr_b16 a[142:143], v21 offset:25600
    ds_read_b64_tr_b16 a[144:145], v20 offset:32768
    ds_read_b64_tr_b16 a[146:147], v20 offset:33792
    ds_read_b64_tr_b16 a[148:149], v21 offset:32768
    ds_read_b64_tr_b16 a[150:151], v21 offset:33792
    ds_read_b64_tr_b16 a[152:153], v20 offset:40960
    ds_read_b64_tr_b16 a[154:155], v20 offset:41984
    ds_read_b64_tr_b16 a[156:157], v21 offset:40960
    ds_read_b64_tr_b16 a[158:159], v21 offset:41984
    s_waitcnt lgkmcnt(3)
    ds_read_b64_tr_b16 a[160:161], v20 offset:49152
    ds_read_b64_tr_b16 a[162:163], v20 offset:50176
    ds_read_b64_tr_b16 a[164:165], v21 offset:49152
    ds_read_b64_tr_b16 a[166:167], v21 offset:50176
    ds_read_b64_tr_b16 a[168:169], v22 offset:0
    ds_read_b64_tr_b16 a[170:171], v22 offset:1024
    ds_read_b64_tr_b16 a[172:173], v23 offset:0
    ds_read_b64_tr_b16 a[174:175], v23 offset:1024
    ds_read_b64_tr_b16 a[176:177], v22 offset:8192
    ds_read_b64_tr_b16 a[178:179], v22 offset:9216
    ds_read_b64_tr_b16 a[180:181], v23 offset:8192
    ds_read_b64_tr_b16 a[182:183], v23 offset:9216
    s_waitcnt lgkmcnt(3)
    ds_read_b64_tr_b16 a[184:185], v22 offset:16384
    ds_read_b64_tr_b16 a[186:187], v22 offset:17408
    ds_read_b64_tr_b16 a[188:189], v23 offset:16384
    ds_read_b64_tr_b16 a[190:191], v23 offset:17408
    ds_read_b64_tr_b16 a[192:193], v22 offset:24576
    ds_read_b64_tr_b16 a[194:195], v22 offset:25600
    ds_read_b64_tr_b16 a[196:197], v23 offset:24576
    ds_read_b64_tr_b16 a[198:199], v23 offset:25600
    ds_read_b64_tr_b16 a[200:201], v22 offset:32768
    ds_read_b64_tr_b16 a[202:203], v22 offset:33792
    ds_read_b64_tr_b16 a[204:205], v23 offset:32768
    ds_read_b64_tr_b16 a[206:207], v23 offset:33792
    s_waitcnt lgkmcnt(3)
    ds_read_b64_tr_b16 a[208:209], v22 offset:40960
    ds_read_b64_tr_b16 a[210:211], v22 offset:41984
    ds_read_b64_tr_b16 a[212:213], v23 offset:40960
    ds_read_b64_tr_b16 a[214:215], v23 offset:41984
    ds_read_b64_tr_b16 a[216:217], v22 offset:49152
    ds_read_b64_tr_b16 a[218:219], v22 offset:50176
    ds_read_b64_tr_b16 a[220:221], v23 offset:49152
    ds_read_b64_tr_b16 a[222:223], v23 offset:50176
    s_waitcnt lgkmcnt(0)
    s_barrier
    s_lshr_b32 s38, s49, 1
    s_lshl_b32 s38, s38, 2
    s_add_u32 s38, s38, s3
    s_mul_i32 s38, s38, 57344
    s_and_b32 s39, s49, 1
    s_lshl_b32 s39, s39, 9
    s_add_u32 s38, s38, s39
    s_add_u32 s39, s38, 0
    buffer_load_dwordx4 v[160:163], v2, s[16:19], s39 offen nt
    s_add_u32 s39, s38, 3584
    buffer_load_dwordx4 v[164:167], v2, s[16:19], s39 offen nt
    s_add_u32 s39, s38, 7168
    buffer_load_dwordx4 v[168:171], v2, s[16:19], s39 offen nt
    s_add_u32 s39, s38, 10752
    buffer_load_dwordx4 v[172:175], v2, s[16:19], s39 offen nt
    s_add_u32 s39, s38, 14336
    buffer_load_dwordx4 v[176:179], v2, s[16:19], s39 offen nt
    s_add_u32 s39, s38, 17920
    buffer_load_dwordx4 v[180:183], v2, s[16:19], s39 offen nt
    s_add_u32 s39, s38, 21504
    buffer_load_dwordx4 v[184:187], v2, s[16:19], s39 offen nt
    s_add_u32 s39, s38, 25088
    buffer_load_dwordx4 v[188:191], v2, s[16:19], s39 offen nt
    s_add_u32 s39, s38, 28672
    buffer_load_dwordx4 v[192:195], v2, s[16:19], s39 offen nt
    s_add_u32 s39, s38, 32256
    buffer_load_dwordx4 v[196:199], v2, s[16:19], s39 offen nt
    s_add_u32 s39, s38, 35840
    buffer_load_dwordx4 v[200:203], v2, s[16:19], s39 offen nt
    s_add_u32 s39, s38, 39424
    buffer_load_dwordx4 v[204:207], v2, s[16:19], s39 offen nt
    s_add_u32 s39, s38, 43008
    buffer_load_dwordx4 v[208:211], v2, s[16:19], s39 offen nt
    s_add_u32 s39, s38, 46592
    buffer_load_dwordx4 v[212:215], v2, s[16:19], s39 offen nt
    s_add_u32 s39, s38, 50176
    buffer_load_dwordx4 v[216:219], v2, s[16:19], s39 offen nt
    s_add_u32 s39, s38, 53760
    buffer_load_dwordx4 v[220:223], v2, s[16:19], s39 offen nt
    s_lshr_b32 s38, s49, 1
    s_lshl_b32 s38, s38, 2
    s_add_u32 s38, s38, s3
    s_mul_i32 s38, s38, 57344
    s_and_b32 s39, s49, 1
    s_lshl_b32 s39, s39, 9
    s_add_u32 s38, s38, s39
    s_lshl_b32 s40, s3, 14
    s_add_u32 s40, s40, 65536
    s_add_u32 s39, s38, 256
    s_add_u32 s41, s40, 0
    s_mov_b32 m0, s41
    s_nop 0
    buffer_load_dwordx4 v91, s[16:19], s39 offen nt lds
    s_add_u32 s39, s38, 3840
    s_add_u32 s41, s40, 1024
    s_mov_b32 m0, s41
    s_nop 0
    buffer_load_dwordx4 v91, s[16:19], s39 offen nt lds
    s_add_u32 s39, s38, 7424
    s_add_u32 s41, s40, 2048
    s_mov_b32 m0, s41
    s_nop 0
    buffer_load_dwordx4 v91, s[16:19], s39 offen nt lds
    s_add_u32 s39, s38, 11008
    s_add_u32 s41, s40, 3072
    s_mov_b32 m0, s41
    s_nop 0
    buffer_load_dwordx4 v91, s[16:19], s39 offen nt lds
    s_add_u32 s39, s38, 14592
    s_add_u32 s41, s40, 4096
    s_mov_b32 m0, s41
    s_nop 0
    buffer_load_dwordx4 v91, s[16:19], s39 offen nt lds
    s_add_u32 s39, s38, 18176
    s_add_u32 s41, s40, 5120
    s_mov_b32 m0, s41
    s_nop 0
    buffer_load_dwordx4 v91, s[16:19], s39 offen nt lds
    s_add_u32 s39, s38, 21760
    s_add_u32 s41, s40, 6144
    s_mov_b32 m0, s41
    s_nop 0
    buffer_load_dwordx4 v91, s[16:19], s39 offen nt lds
    s_add_u32 s39, s38, 25344
    s_add_u32 s41, s40, 7168
    s_mov_b32 m0, s41
    s_nop 0
    buffer_load_dwordx4 v91, s[16:19], s39 offen nt lds
    s_add_u32 s39, s38, 28928
    s_add_u32 s41, s40, 8192
    s_mov_b32 m0, s41
    s_nop 0
    buffer_load_dwordx4 v91, s[16:19], s39 offen nt lds
    s_add_u32 s39, s38, 32512
    s_add_u32 s41, s40, 9216
    s_mov_b32 m0, s41
    s_nop 0
    buffer_load_dwordx4 v91, s[16:19], s39 offen nt lds
    s_add_u32 s39, s38, 36096
    s_add_u32 s41, s40, 10240
    s_mov_b32 m0, s41
    s_nop 0
    buffer_load_dwordx4 v91, s[16:19], s39 offen nt lds
    s_add_u32 s39, s38, 39680
    s_add_u32 s41, s40, 11264
    s_mov_b32 m0, s41
    s_nop 0
    buffer_load_dwordx4 v91, s[16:19], s39 offen nt lds
    s_add_u32 s39, s38, 43264
    s_add_u32 s41, s40, 12288
    s_mov_b32 m0, s41
    s_nop 0
    buffer_load_dwordx4 v91, s[16:19], s39 offen nt lds
    s_add_u32 s39, s38, 46848
    s_add_u32 s41, s40, 13312
    s_mov_b32 m0, s41
    s_nop 0
    buffer_load_dwordx4 v91, s[16:19], s39 offen nt lds
    s_add_u32 s39, s38, 50432
    s_add_u32 s41, s40, 14336
    s_mov_b32 m0, s41
    s_nop 0
    buffer_load_dwordx4 v91, s[16:19], s39 offen nt lds
    s_add_u32 s39, s38, 54016
    s_add_u32 s41, s40, 15360
    s_mov_b32 m0, s41
    s_nop 0
    buffer_load_dwordx4 v91, s[16:19], s39 offen nt lds
    v_mov_b32 v20, 0x3f803f80
    v_mov_b32 v21, 0x3f803f80
    v_mov_b32 v22, 0x3f803f80
    v_mov_b32 v23, 0x3f803f80
    s_nop 1
    v_mfma_f32_16x16x32_bf16 v[28:31], v[20:23], a[112:115], 0
    v_mfma_f32_16x16x32_bf16 v[32:35], v[20:23], a[116:119], 0
    v_mfma_f32_16x16x32_bf16 v[28:31], v[20:23], a[120:123], v[28:31]
    v_mfma_f32_16x16x32_bf16 v[32:35], v[20:23], a[124:127], v[32:35]
    v_mfma_f32_16x16x32_bf16 v[28:31], v[20:23], a[128:131], v[28:31]
    v_mfma_f32_16x16x32_bf16 v[32:35], v[20:23], a[132:135], v[32:35]
    v_mfma_f32_16x16x32_bf16 v[28:31], v[20:23], a[136:139], v[28:31]
    v_mfma_f32_16x16x32_bf16 v[32:35], v[20:23], a[140:143], v[32:35]
    v_mfma_f32_16x16x32_bf16 v[28:31], v[20:23], a[144:147], v[28:31]
    v_mfma_f32_16x16x32_bf16 v[32:35], v[20:23], a[148:151], v[32:35]
    v_mfma_f32_16x16x32_bf16 v[28:31], v[20:23], a[152:155], v[28:31]
    v_mfma_f32_16x16x32_bf16 v[32:35], v[20:23], a[156:159], v[32:35]
    v_mfma_f32_16x16x32_bf16 v[28:31], v[20:23], a[160:163], v[28:31]
    v_mfma_f32_16x16x32_bf16 v[32:35], v[20:23], a[164:167], v[32:35]
    v_mfma_f32_16x16x32_bf16 v[28:31], v[20:23], a[168:171], v[28:31]
    v_mfma_f32_16x16x32_bf16 v[32:35], v[20:23], a[172:175], v[32:35]
    v_mfma_f32_16x16x32_bf16 v[28:31], v[20:23], a[176:179], v[28:31]
    v_mfma_f32_16x16x32_bf16 v[32:35], v[20:23], a[180:183], v[32:35]
    v_mfma_f32_16x16x32_bf16 v[28:31], v[20:23], a[184:187], v[28:31]
    v_mfma_f32_16x16x32_bf16 v[32:35], v[20:23], a[188:191], v[32:35]
    v_mfma_f32_16x16x32_bf16 v[28:31], v[20:23], a[192:195], v[28:31]
    v_mfma_f32_16x16x32_bf16 v[32:35], v[20:23], a[196:199], v[32:35]
    v_mfma_f32_16x16x32_bf16 v[28:31], v[20:23], a[200:203], v[28:31]
    v_mfma_f32_16x16x32_bf16 v[32:35], v[20:23], a[204:207], v[32:35]
    v_mfma_f32_16x16x32_bf16 v[28:31], v[20:23], a[208:211], v[28:31]
    v_mfma_f32_16x16x32_bf16 v[32:35], v[20:23], a[212:215], v[32:35]
    v_mfma_f32_16x16x32_bf16 v[28:31], v[20:23], a[216:219], v[28:31]
    v_mfma_f32_16x16x32_bf16 v[32:35], v[20:23], a[220:223], v[32:35]
    s_nop 7
    v_mov_b32 v93, v28
    s_mov_b32 exec_lo, 0xffff0000
    s_mov_b32 exec_hi, 0xffff0000
    v_mov_b32 v93, v32
    s_mov_b64 exec, -1
    s_waitcnt vmcnt(32)
    s_lshl_b32 s39, s3, 14
    v_add_u32 v7, s39, v5
    ds_write_b128 v7, v[224:227] offset:0
    ds_write_b128 v7, v[228:231] offset:1024
    ds_write_b128 v7, v[232:235] offset:2048
    ds_write_b128 v7, v[236:239] offset:3072
    ds_write_b128 v7, v[240:243] offset:4096
    ds_write_b128 v7, v[244:247] offset:5120
    ds_write_b128 v7, v[248:251] offset:6144
    ds_write_b128 v7, v[252:255] offset:7168
    ds_write_b128 v7, a[224:227] offset:8192
    ds_write_b128 v7, a[228:231] offset:9216
    ds_write_b128 v7, a[232:235] offset:10240
    ds_write_b128 v7, a[236:239] offset:11264
    ds_write_b128 v7, a[240:243] offset:12288
    ds_write_b128 v7, a[244:247] offset:13312
    ds_write_b128 v7, a[248:251] offset:14336
    ds_write_b128 v7, a[252:255] offset:15360
    s_waitcnt lgkmcnt(0)
L_ch_cnt:
    s_cmp_eq_u32 s43, 0
    s_cbranch_scc1 L_ch_cnt_ok
    s_sub_u32 s43, s43, 1
    v_lshlrev_b32 v7, 2, v0
    buffer_load_dword v36, v7, s[24:27], 0 offen sc1
    s_waitcnt vmcnt(0)
    v_add_u32 v37, 0x7f7f7f7f, v36
    v_and_b32 v37, 0x80808080, v37
    v_cmp_ne_u32 vcc, 0x80808080, v37
    s_nop 0
    s_cmp_lg_u64 vcc, 0
    s_cbranch_scc1 L_ch_cnt
L_ch_cnt_ok:
L_ch_pre:
    s_cmp_eq_u32 s43, 0
    s_cbranch_scc1 L_ch_stageA
    s_sub_u32 s43, s43, 1
L_ch_pre_s:
    s_getpc_b64 s[38:39]
L_pc_39:
    s_add_u32 s38, s38, L_ch_stageA-L_pc_39
    s_addc_u32 s39, s39, -1
    v_lshlrev_b32 v7, 6, v0
    global_load_dword v36, v7, s[38:39]
    v_add_u32 v7, 4096, v7
    v_min_u32 v7, 5312, v7
    global_load_dword v36, v7, s[38:39]
    s_sleep 16
L_ch_pre_p:
    s_mov_b64 exec, 1
    buffer_load_dword v64, v4, s[20:23], s46 offen sc1
    s_waitcnt vmcnt(0)
    v_readfirstlane_b32 s38, v64
    s_mov_b64 exec, -1
    s_cmp_eq_u32 s38, -1
    s_cbranch_scc1 L_ch_pre
    s_branch L_ch_stageA
L_ch_out:
    v_subrev_u32 v7, 135168, v17
    buffer_store_dword v68, v7, s[28:31], 0 offen
L_fin:
L_end:
    s_endpgm
.section .rodata,"a"
.p2align 6
.amdhsa_kernel interleave_layers__gqa_block_cached__sliding_block_cached__decode_kernel
  .amdhsa_next_free_vgpr 512
  .amdhsa_next_free_sgpr 102
  .amdhsa_accum_offset 256
  .amdhsa_group_segment_fixed_size 0
  .amdhsa_kernarg_size 104
  .amdhsa_user_sgpr_count 2
  .amdhsa_user_sgpr_kernarg_segment_ptr 1
  .amdhsa_system_sgpr_workgroup_id_x 1
  .amdhsa_float_denorm_mode_32 3
.end_amdhsa_kernel
```
